```python
import torch

def _softmax(x, axis=-1):
    return torch.softmax(x, dim=axis)
def _gelu(x):
    return torch.nn.functional.gelu(x, approximate="tanh")
def _silu(x):
    return torch.nn.functional.silu(x)
def _sigmoid(x):
    return torch.sigmoid(x)
def _layernorm(x, axis=-1, eps=1e-5):
    m = x.mean(dim=axis, keepdim=True)
    v = x.var(dim=axis, keepdim=True, unbiased=False)
    return (x - m) / torch.sqrt(v + eps)
def _scatter_add(tgt, idx, src, axis=0):
    return tgt.clone().index_add_(axis, idx, src)
def _segment_sum(src, seg, n):
    out = torch.zeros((n,) + src.shape[1:], dtype=src.dtype)
    return out.index_add_(0, seg, src)
def _pad(x, pw):
    flat = tuple(v for pair in reversed(pw) for v in pair)
    return torch.nn.functional.pad(x, flat)

kernel_name = 'sequential_preLN__linear_kernel_hedgehog__glu_gated_glu__prompt'

def setup_inputs():

    _w = (lambda a: (lambda t: t.to(torch.bfloat16) if t.is_floating_point() else t)(torch.as_tensor(a)))
    def _A_setup():
        B, S, D, H = 1, 2048, 512, 32
        Dh = D // H
        return {
            "x": _w((lambda *s: torch.randn(*s, dtype=torch.bfloat16) * 0.05)(B, S, D)),
            "wqkv": _w((lambda *s: torch.randn(*s, dtype=torch.bfloat16) * 0.2)(D, 3 * D)),
            "w_phi": _w((lambda *s: torch.randn(*s, dtype=torch.bfloat16) * 0.2)(H, Dh, Dh) * (Dh ** -0.5)),
            "wo": _w((lambda *s: torch.randn(*s, dtype=torch.bfloat16) * 0.05)(D, D)),
        }
    _A_in = _A_setup()

    def _B_setup():
        B, S, D, F = 1, 2048, 512, 1792
        return {
            "x": _w((lambda *s: torch.randn(*s, dtype=torch.bfloat16) * 0.05)(B, S, D)),
            "w_gate": _w((lambda *s: torch.randn(*s, dtype=torch.bfloat16) * 0.05)(D, F)),
            "w_up": _w((lambda *s: torch.randn(*s, dtype=torch.bfloat16) * 0.05)(D, F)),
            "w_down": _w((lambda *s: torch.randn(*s, dtype=torch.bfloat16) * 0.05)(F, D)),
        }
    _B_in = _B_setup()

    return {
        "A_x": _A_in["x"],
        "A_wqkv": _A_in["wqkv"],
        "A_w_phi": _A_in["w_phi"],
        "A_wo": _A_in["wo"],
        "B_x": _B_in["x"],
        "B_w_gate": _B_in["w_gate"],
        "B_w_up": _B_in["w_up"],
        "B_w_down": _B_in["w_down"],
    }

def reference(A_x, A_wqkv, A_w_phi, A_wo, B_x, B_w_gate, B_w_up, B_w_down):
    def _A_ref(x, wqkv, w_phi, wo):
        B, S, D = x.shape
        H = 32; Dh = D // H
        qkv = (lambda x, *d: x.permute(*d))((x @ wqkv).reshape(B, S, 3, H, Dh), 2, 0, 3, 1, 4)
        q, k, v = qkv[0], qkv[1], qkv[2]
        pq = torch.einsum("bhsd,hdf->bhsf", q, w_phi)
        pk = torch.einsum("bhsd,hdf->bhsf", k, w_phi)
        phi_q = torch.concatenate([_softmax(pq, axis=-1), _softmax(-pq, axis=-1)], axis=-1)
        phi_k = torch.concatenate([_softmax(pk, axis=-1), _softmax(-pk, axis=-1)], axis=-1)
        kv = torch.einsum("bhsf,bhsd->bhfd", phi_k, v)
        z  = torch.einsum("bhsf->bhf", phi_k)
        num = torch.einsum("bhqf,bhfd->bhqd", phi_q, kv)
        den = torch.einsum("bhqf,bhf->bhq", phi_q, z)[..., None] + 1e-6
        o = num / den
        return (lambda x, *d: x.permute(*d))(o, 0, 2, 1, 3).reshape(B, S, D) @ wo

    def _B_ref(x, w_gate, w_up, w_down):
        g = torch.einsum("bsd,df->bsf", x, w_gate)
        u = torch.einsum("bsd,df->bsf", x, w_up)
        h = _sigmoid(g) * u
        return torch.einsum("bsf,fd->bsd", h, w_down)

    x = A_x
    h = x + _A_ref(_layernorm(x, axis=-1), A_wqkv, A_w_phi, A_wo)
    h2 = h + _B_ref(_layernorm(h, axis=-1), B_w_gate, B_w_up, B_w_down)
    return h2
```

```asm
; @launch grid=(256,1,1) block=(512,1,1) lds=163840
.amdgcn_target "amdgcn-amd-amdhsa--gfx950"
.text
.globl sequential_preLN__linear_kernel_hedgehog__glu_gated_glu__prompt_kernel
.p2align 8
.type sequential_preLN__linear_kernel_hedgehog__glu_gated_glu__prompt_kernel,@function
sequential_preLN__linear_kernel_hedgehog__glu_gated_glu__prompt_kernel:
    s_cmp_ge_u32 s2, 256
    s_cbranch_scc1 ALL_EXIT
    s_load_dwordx8 s[4:11], s[0:1], 0
    s_load_dwordx8 s[12:19], s[0:1], 40
    s_load_dwordx4 s[20:23], s[0:1], 72
    v_lshrrev_b32 v1, 6, v0
    v_and_b32 v0, 63, v0
    v_readfirstlane_b32 s24, v1
    s_nop 3
    s_and_b32 s25, s24, 3
    s_and_b32 s44, s2, 7
    s_lshr_b32 s45, s2, 3
    s_and_b32 s56, s44, 3
    s_lshl_b32 s56, s56, 3
    s_and_b32 s46, s45, 7
    s_add_u32 s56, s56, s46
    s_lshr_b32 s57, s44, 2
    s_lshl_b32 s57, s57, 2
    s_lshr_b32 s47, s45, 3
    s_add_u32 s57, s57, s47
    s_and_b32 s58, s46, 7
    v_mov_b32 v12, 0x3fb8aa3b
    s_cmp_eq_u32 s24, 4
    s_cbranch_scc0 P1_NOCPF
    s_getpc_b64 s[62:63]
P1_PC:
    s_sub_u32 s62, s62, P1_PC-sequential_preLN__linear_kernel_hedgehog__glu_gated_glu__prompt_kernel
    s_subb_u32 s63, s63, 0
    s_lshr_b32 s46, s2, 3
    s_mul_i32 s46, s46, 12
    v_add_u32 v3, s46, v0
    v_lshlrev_b32 v3, 7, v3
    v_cmp_gt_u32 vcc, 12, v0
    s_and_saveexec_b64 s[48:49], vcc
    s_mov_b32 s46, ALL_END-sequential_preLN__linear_kernel_hedgehog__glu_gated_glu__prompt_kernel
    v_cmp_gt_u32 vcc, s46, v3
    s_and_b64 exec, exec, vcc
    s_cbranch_execz P1_CPFX
    global_load_dword v255, v3, s[62:63]
P1_CPFX:
    s_mov_b64 exec, s[48:49]
P1_NOCPF:
    s_cmp_ge_u32 s24, 4
    s_cbranch_scc1 P1_NOX
    v_lshrrev_b32 v212, 3, v0
    v_lshlrev_b32 v212, 10, v212
    v_and_b32 v213, 7, v0
    v_lshl_add_u32 v212, v213, 4, v212
    s_lshl_b32 s3, s56, 2
    s_add_u32 s3, s3, s25
    s_lshl_b32 s3, s3, 14
    s_waitcnt lgkmcnt(0)
    s_mov_b32 s32, s4
    s_and_b32 s33, s5, 0xffff
    s_mov_b32 s34, 2097152
    s_mov_b32 s35, 0x20000
    buffer_load_dwordx4 v[80:83], v212, s[32:35], s3 offen offset:0
    buffer_load_dwordx4 v[84:87], v212, s[32:35], s3 offen offset:128
    buffer_load_dwordx4 v[88:91], v212, s[32:35], s3 offen offset:256
    buffer_load_dwordx4 v[92:95], v212, s[32:35], s3 offen offset:384
    buffer_load_dwordx4 v[96:99], v212, s[32:35], s3 offen offset:512
    buffer_load_dwordx4 v[100:103], v212, s[32:35], s3 offen offset:640
    buffer_load_dwordx4 v[104:107], v212, s[32:35], s3 offen offset:768
    buffer_load_dwordx4 v[108:111], v212, s[32:35], s3 offen offset:896
    s_add_u32 s3, s3, 8192
    buffer_load_dwordx4 v[112:115], v212, s[32:35], s3 offen offset:0
    buffer_load_dwordx4 v[116:119], v212, s[32:35], s3 offen offset:128
    buffer_load_dwordx4 v[120:123], v212, s[32:35], s3 offen offset:256
    buffer_load_dwordx4 v[124:127], v212, s[32:35], s3 offen offset:384
    buffer_load_dwordx4 v[128:131], v212, s[32:35], s3 offen offset:512
    buffer_load_dwordx4 v[132:135], v212, s[32:35], s3 offen offset:640
    buffer_load_dwordx4 v[136:139], v212, s[32:35], s3 offen offset:768
    buffer_load_dwordx4 v[140:143], v212, s[32:35], s3 offen offset:896
P1_NOX:
    s_cmp_ge_u32 s24, 4
    s_cbranch_scc0 P1_CONS
    v_lshrrev_b32 v84, 3, v0
    v_add_u32 v84, 0, v84
    v_mul_u32_u24 v85, 43, v84
    v_lshrrev_b32 v85, 7, v85
    v_mul_u32_u24 v86, 3, v85
    v_sub_u32 v84, v84, v86
    v_bfe_u32 v86, v85, 1, 1
    v_lshlrev_b32 v86, 2, v86
    v_and_b32 v87, 7, v0
    v_xor_b32 v86, v86, v87
    v_mul_u32_u24 v85, 3072, v85
    v_lshl_add_u32 v85, v84, 10, v85
    v_lshl_add_u32 v80, v86, 4, v85
    v_lshrrev_b32 v84, 3, v0
    v_add_u32 v84, 8, v84
    v_mul_u32_u24 v85, 43, v84
    v_lshrrev_b32 v85, 7, v85
    v_mul_u32_u24 v86, 3, v85
    v_sub_u32 v84, v84, v86
    v_bfe_u32 v86, v85, 1, 1
    v_lshlrev_b32 v86, 2, v86
    v_and_b32 v87, 7, v0
    v_xor_b32 v86, v86, v87
    v_mul_u32_u24 v85, 3072, v85
    v_lshl_add_u32 v85, v84, 10, v85
    v_lshl_add_u32 v81, v86, 4, v85
    v_lshrrev_b32 v84, 3, v0
    v_add_u32 v84, 16, v84
    v_mul_u32_u24 v85, 43, v84
    v_lshrrev_b32 v85, 7, v85
    v_mul_u32_u24 v86, 3, v85
    v_sub_u32 v84, v84, v86
    v_bfe_u32 v86, v85, 1, 1
    v_lshlrev_b32 v86, 2, v86
    v_and_b32 v87, 7, v0
    v_xor_b32 v86, v86, v87
    v_mul_u32_u24 v85, 3072, v85
    v_lshl_add_u32 v85, v84, 10, v85
    v_lshl_add_u32 v82, v86, 4, v85
    s_mul_i32 s60, s25, 49152
    s_lshl_b32 s46, s57, 7
    s_add_u32 s60, s60, s46
    s_mul_i32 s61, s25, 6144
    s_add_u32 s61, s61, 73728
    s_mov_b32 s62, s58
    s_waitcnt lgkmcnt(0)
    s_mov_b32 s32, s4
    s_and_b32 s33, s5, 0xffff
    s_mov_b32 s34, 2097152
    s_mov_b32 s35, 0x20000
    s_mov_b32 s36, s6
    s_and_b32 s37, s7, 0xffff
    s_mov_b32 s38, 1572864
    s_mov_b32 s39, 0x20000
    s_mov_b32 s40, s8
    s_and_b32 s41, s9, 0xffff
    s_mov_b32 s42, 16384
    s_mov_b32 s43, 0x20000
    s_mov_b32 s28, s22
    s_and_b32 s29, s23, 0xffff
    s_mov_b32 s30, 268435456
    s_mov_b32 s31, 0x20000
    s_barrier
    s_mul_i32 s63, s62, 196608
    s_add_u32 s63, s63, s60
    s_add_u32 s62, s62, 1
    s_and_b32 s62, s62, 7
    s_add_u32 m0, s61, 0
    s_nop 0
    buffer_load_dwordx4 v80, s[36:39], s63 offen lds
    s_add_u32 m0, s61, 1024
    s_nop 0
    buffer_load_dwordx4 v81, s[36:39], s63 offen lds
    s_add_u32 m0, s61, 2048
    s_nop 0
    buffer_load_dwordx4 v82, s[36:39], s63 offen lds
    s_add_u32 m0, s61, 3072
    s_add_u32 s63, s63, 24576
    buffer_load_dwordx4 v80, s[36:39], s63 offen lds
    s_add_u32 m0, s61, 4096
    s_nop 0
    buffer_load_dwordx4 v81, s[36:39], s63 offen lds
    s_add_u32 m0, s61, 5120
    s_nop 0
    buffer_load_dwordx4 v82, s[36:39], s63 offen lds
    s_and_b32 s46, s25, 1
    s_lshl_b32 s46, s46, 10
    s_add_u32 m0, s46, 0
    v_lshlrev_b32 v84, 4, v0
    s_lshl_b32 s47, s57, 11
    s_add_u32 s46, s46, s47
    buffer_load_dwordx4 v84, s[40:43], s46 offen lds
    s_mul_i32 s63, s62, 196608
    s_add_u32 s63, s63, s60
    s_add_u32 s62, s62, 1
    s_and_b32 s62, s62, 7
    s_add_u32 m0, s61, 24576
    s_nop 0
    buffer_load_dwordx4 v80, s[36:39], s63 offen lds
    s_add_u32 m0, s61, 25600
    s_nop 0
    buffer_load_dwordx4 v81, s[36:39], s63 offen lds
    s_add_u32 m0, s61, 26624
    s_nop 0
    buffer_load_dwordx4 v82, s[36:39], s63 offen lds
    s_add_u32 m0, s61, 27648
    s_add_u32 s63, s63, 24576
    buffer_load_dwordx4 v80, s[36:39], s63 offen lds
    s_add_u32 m0, s61, 28672
    s_nop 0
    buffer_load_dwordx4 v81, s[36:39], s63 offen lds
    s_add_u32 m0, s61, 29696
    s_nop 0
    buffer_load_dwordx4 v82, s[36:39], s63 offen lds
    s_waitcnt vmcnt(6)
    s_waitcnt lgkmcnt(0)
    s_barrier
    s_mul_i32 s63, s62, 196608
    s_add_u32 s63, s63, s60
    s_add_u32 s62, s62, 1
    s_and_b32 s62, s62, 7
    s_add_u32 m0, s61, 49152
    s_nop 0
    buffer_load_dwordx4 v80, s[36:39], s63 offen lds
    s_add_u32 m0, s61, 50176
    s_nop 0
    buffer_load_dwordx4 v81, s[36:39], s63 offen lds
    s_add_u32 m0, s61, 51200
    s_nop 0
    buffer_load_dwordx4 v82, s[36:39], s63 offen lds
    s_add_u32 m0, s61, 52224
    s_add_u32 s63, s63, 24576
    buffer_load_dwordx4 v80, s[36:39], s63 offen lds
    s_add_u32 m0, s61, 53248
    s_nop 0
    buffer_load_dwordx4 v81, s[36:39], s63 offen lds
    s_add_u32 m0, s61, 54272
    s_nop 0
    buffer_load_dwordx4 v82, s[36:39], s63 offen lds
    v_lshrrev_b32 v4, 5, v0
    v_bfe_u32 v5, v0, 2, 2
    v_lshlrev_b32 v5, 5, v5
    v_lshl_add_u32 v5, v4, 9, v5
    v_bfe_u32 v6, v0, 1, 1
    v_bfe_u32 v7, v0, 4, 1
    v_lshl_add_u32 v6, v7, 1, v6
    v_lshl_add_u32 v5, v6, 3, v5
    s_lshr_b32 s46, s25, 1
    s_lshl_b32 s46, s46, 10
    s_add_u32 s46, s46, 0
    v_add_u32 v5, s46, v5
    v_and_b32 v6, 1, v0
    v_cmp_eq_u32 vcc, v6, v4
    v_mov_b32 v7, 2048
    s_nop 0
    v_add_u32 v6, 0, v5
    v_cndmask_b32 v6, v7, v6, vcc
    ds_read_b64_tr_b16 v[16:17], v6
    v_add_u32 v6, 128, v5
    v_cndmask_b32 v6, v7, v6, vcc
    ds_read_b64_tr_b16 v[18:19], v6
    v_add_u32 v6, 256, v5
    v_cndmask_b32 v6, v7, v6, vcc
    ds_read_b64_tr_b16 v[20:21], v6
    v_add_u32 v6, 384, v5
    v_cndmask_b32 v6, v7, v6, vcc
    ds_read_b64_tr_b16 v[22:23], v6
    s_waitcnt vmcnt(6)
    s_barrier
    s_mul_i32 s63, s62, 196608
    s_add_u32 s63, s63, s60
    s_add_u32 s62, s62, 1
    s_and_b32 s62, s62, 7
    s_add_u32 m0, s61, 0
    s_nop 0
    buffer_load_dwordx4 v80, s[36:39], s63 offen lds
    s_add_u32 m0, s61, 1024
    s_nop 0
    buffer_load_dwordx4 v81, s[36:39], s63 offen lds
    s_add_u32 m0, s61, 2048
    s_nop 0
    buffer_load_dwordx4 v82, s[36:39], s63 offen lds
    s_add_u32 m0, s61, 3072
    s_add_u32 s63, s63, 24576
    buffer_load_dwordx4 v80, s[36:39], s63 offen lds
    s_add_u32 m0, s61, 4096
    s_nop 0
    buffer_load_dwordx4 v81, s[36:39], s63 offen lds
    s_add_u32 m0, s61, 5120
    s_nop 0
    buffer_load_dwordx4 v82, s[36:39], s63 offen lds
    s_waitcnt vmcnt(6)
    s_barrier
    s_mul_i32 s63, s62, 196608
    s_add_u32 s63, s63, s60
    s_add_u32 s62, s62, 1
    s_and_b32 s62, s62, 7
    s_add_u32 m0, s61, 24576
    s_nop 0
    buffer_load_dwordx4 v80, s[36:39], s63 offen lds
    s_add_u32 m0, s61, 25600
    s_nop 0
    buffer_load_dwordx4 v81, s[36:39], s63 offen lds
    s_add_u32 m0, s61, 26624
    s_nop 0
    buffer_load_dwordx4 v82, s[36:39], s63 offen lds
    s_add_u32 m0, s61, 27648
    s_add_u32 s63, s63, 24576
    buffer_load_dwordx4 v80, s[36:39], s63 offen lds
    s_add_u32 m0, s61, 28672
    s_nop 0
    buffer_load_dwordx4 v81, s[36:39], s63 offen lds
    s_add_u32 m0, s61, 29696
    s_nop 0
    buffer_load_dwordx4 v82, s[36:39], s63 offen lds
    s_waitcnt vmcnt(6)
    s_barrier
    s_mul_i32 s63, s62, 196608
    s_add_u32 s63, s63, s60
    s_add_u32 s62, s62, 1
    s_and_b32 s62, s62, 7
    s_add_u32 m0, s61, 49152
    s_nop 0
    buffer_load_dwordx4 v80, s[36:39], s63 offen lds
    s_add_u32 m0, s61, 50176
    s_nop 0
    buffer_load_dwordx4 v81, s[36:39], s63 offen lds
    s_add_u32 m0, s61, 51200
    s_nop 0
    buffer_load_dwordx4 v82, s[36:39], s63 offen lds
    s_add_u32 m0, s61, 52224
    s_add_u32 s63, s63, 24576
    buffer_load_dwordx4 v80, s[36:39], s63 offen lds
    s_add_u32 m0, s61, 53248
    s_nop 0
    buffer_load_dwordx4 v81, s[36:39], s63 offen lds
    s_add_u32 m0, s61, 54272
    s_nop 0
    buffer_load_dwordx4 v82, s[36:39], s63 offen lds
    s_waitcnt vmcnt(6)
    s_barrier
    s_mul_i32 s63, s62, 196608
    s_add_u32 s63, s63, s60
    s_add_u32 s62, s62, 1
    s_and_b32 s62, s62, 7
    s_add_u32 m0, s61, 0
    s_nop 0
    buffer_load_dwordx4 v80, s[36:39], s63 offen lds
    s_add_u32 m0, s61, 1024
    s_nop 0
    buffer_load_dwordx4 v81, s[36:39], s63 offen lds
    s_add_u32 m0, s61, 2048
    s_nop 0
    buffer_load_dwordx4 v82, s[36:39], s63 offen lds
    s_add_u32 m0, s61, 3072
    s_add_u32 s63, s63, 24576
    buffer_load_dwordx4 v80, s[36:39], s63 offen lds
    s_add_u32 m0, s61, 4096
    s_nop 0
    buffer_load_dwordx4 v81, s[36:39], s63 offen lds
    s_add_u32 m0, s61, 5120
    s_nop 0
    buffer_load_dwordx4 v82, s[36:39], s63 offen lds
    s_waitcnt vmcnt(6)
    s_barrier
    s_mul_i32 s63, s62, 196608
    s_add_u32 s63, s63, s60
    s_add_u32 s62, s62, 1
    s_and_b32 s62, s62, 7
    s_add_u32 m0, s61, 24576
    s_nop 0
    buffer_load_dwordx4 v80, s[36:39], s63 offen lds
    s_add_u32 m0, s61, 25600
    s_nop 0
    buffer_load_dwordx4 v81, s[36:39], s63 offen lds
    s_add_u32 m0, s61, 26624
    s_nop 0
    buffer_load_dwordx4 v82, s[36:39], s63 offen lds
    s_add_u32 m0, s61, 27648
    s_add_u32 s63, s63, 24576
    buffer_load_dwordx4 v80, s[36:39], s63 offen lds
    s_add_u32 m0, s61, 28672
    s_nop 0
    buffer_load_dwordx4 v81, s[36:39], s63 offen lds
    s_add_u32 m0, s61, 29696
    s_nop 0
    buffer_load_dwordx4 v82, s[36:39], s63 offen lds
    s_lshr_b32 s45, s2, 3
    s_cmp_ge_u32 s45, 14
    s_cselect_b32 s46, 14, 0
    s_cselect_b32 s44, 1, 0
    s_cselect_b32 s54, s14, s12
    s_cselect_b32 s55, s15, s13
    s_sub_u32 s46, s45, s46
    s_mov_b32 s40, s54
    s_and_b32 s41, s55, 0xffff
    s_mov_b32 s42, 1835008
    s_mov_b32 s43, 0x20000
    s_bfe_u32 s47, s2, 0x10002
    s_mul_i32 s47, s47, 14
    s_add_u32 s46, s46, s47
    s_and_b32 s47, s2, 3
    s_lshl_b32 s47, s47, 2
    s_add_u32 s47, s47, s25
    s_mul_i32 s51, s47, 3584
    s_mul_i32 s44, s44, 1792
    s_add_u32 s51, s51, s44
    s_lshl_b32 s44, s46, 6
    s_add_u32 s51, s51, s44
    s_lshl_b32 s51, s51, 2
    s_add_u32 s51, s51, 7864320
    s_mul_i32 s47, s47, 114688
    s_lshl_b32 s46, s46, 7
    s_add_u32 s47, s47, s46
    v_lshrrev_b32 v84, 3, v0
    v_mul_u32_u24 v84, 3584, v84
    v_and_b32 v85, 7, v0
    v_lshl_add_u32 v84, v85, 4, v84
    s_cmp_ge_u32 s45, 28
    s_cselect_b32 s47, 0x7f000000, s47
    s_cselect_b32 s51, 0x7f000000, s51
    buffer_load_dwordx4 v[88:91], v84, s[40:43], s47 offen
    s_add_u32 s47, s47, 28672
    buffer_load_dwordx4 v[92:95], v84, s[40:43], s47 offen
    s_add_u32 s47, s47, 28672
    buffer_load_dwordx4 v[96:99], v84, s[40:43], s47 offen
    s_add_u32 s47, s47, 28672
    buffer_load_dwordx4 v[100:103], v84, s[40:43], s47 offen
    s_waitcnt vmcnt(10)
    s_barrier
    s_waitcnt vmcnt(4)
    s_barrier
    s_lshr_b32 s47, s2, 3
    s_cmp_eq_u32 s25, 0
    s_cbranch_scc0 P1_PF1
    s_mov_b32 s40, s10
    s_and_b32 s41, s11, 0xffff
    s_mov_b32 s42, 524288
    s_mov_b32 s43, 0x20000
    v_lshlrev_b32 v84, 7, v0
    s_mul_i32 s46, s47, 16384
    buffer_load_dword v255, v84, s[40:43], s46 offen
    s_add_u32 s46, s46, 8192
    buffer_load_dword v255, v84, s[40:43], s46 offen
    s_mov_b32 s40, s16
    s_and_b32 s41, s17, 0xffff
    s_mov_b32 s42, 1835008
    s_mov_b32 s43, 0x20000
    s_mov_b32 s47, s2
    v_cmp_gt_u32 vcc, 56, v0
    s_and_saveexec_b64 s[48:49], vcc
    s_mul_i32 s46, s47, 7168
    buffer_load_dword v255, v84, s[40:43], s46 offen
    s_mov_b64 exec, s[48:49]
    s_branch P1_PFE
P1_PF1:
    s_mul_i32 s46, s47, 57344
    s_bfe_u32 s47, s2, 0x10002
    s_mul_i32 s47, s47, 1792
    s_add_u32 s46, s46, s47
    s_cmp_eq_u32 s25, 3
    s_cbranch_scc1 P1_PF3
    s_cmp_eq_u32 s25, 1
    s_cselect_b32 s54, s12, s14
    s_cselect_b32 s55, s13, s15
    s_mov_b32 s40, s54
    s_and_b32 s41, s55, 0xffff
    s_mov_b32 s42, 1835008
    s_mov_b32 s43, 0x20000
    s_cmp_eq_u32 s25, 1
    s_cselect_b64 s[48:49], -1, 1
    s_mov_b64 exec, s[48:49]
    v_add_u32 v84, 0, v0
    v_mul_u32_u24 v85, 2341, v84
    v_lshrrev_b32 v85, 15, v85
    v_mul_u32_u24 v86, 14, v85
    v_sub_u32 v84, v84, v86
    v_mul_u32_u24 v85, 3584, v85
    v_lshl_add_u32 v84, v84, 7, v85
    buffer_load_dword v255, v84, s[40:43], s46 offen
    v_add_u32 v84, 64, v0
    v_mul_u32_u24 v85, 2341, v84
    v_lshrrev_b32 v85, 15, v85
    v_mul_u32_u24 v86, 14, v85
    v_sub_u32 v84, v84, v86
    v_mul_u32_u24 v85, 3584, v85
    v_lshl_add_u32 v84, v84, 7, v85
    buffer_load_dword v255, v84, s[40:43], s46 offen
    v_add_u32 v84, 128, v0
    v_mul_u32_u24 v85, 2341, v84
    v_lshrrev_b32 v85, 15, v85
    v_mul_u32_u24 v86, 14, v85
    v_sub_u32 v84, v84, v86
    v_mul_u32_u24 v85, 3584, v85
    v_lshl_add_u32 v84, v84, 7, v85
    buffer_load_dword v255, v84, s[40:43], s46 offen
    s_mov_b64 exec, -1
    s_branch P1_PFE
P1_PF3:
    v_add_u32 v84, 192, v0
    v_mul_u32_u24 v85, 2341, v84
    v_lshrrev_b32 v85, 15, v85
    v_mul_u32_u24 v86, 14, v85
    v_sub_u32 v84, v84, v86
    v_mul_u32_u24 v85, 3584, v85
    v_lshl_add_u32 v84, v84, 7, v85
    v_cmp_gt_u32 vcc, 32, v0
    s_and_saveexec_b64 s[48:49], vcc
    s_mov_b32 s40, s12
    s_and_b32 s41, s13, 0xffff
    s_mov_b32 s42, 1835008
    s_mov_b32 s43, 0x20000
    buffer_load_dword v255, v84, s[40:43], s46 offen
    s_and_b64 exec, exec, 1
    s_mov_b32 s40, s14
    s_and_b32 s41, s15, 0xffff
    s_mov_b32 s42, 1835008
    s_mov_b32 s43, 0x20000
    buffer_load_dword v255, v84, s[40:43], s46 offen
    s_and_b64 exec, exec, 1
    buffer_load_dword v255, v84, s[40:43], s46 offen
    s_mov_b64 exec, s[48:49]
P1_PFE:
    s_lshl_b32 s46, s25, 11
    v_lshlrev_b32 v84, 4, v0
    v_add_u32 v84, s46, v84
    s_mov_b32 s59, 1
    s_barrier
    s_barrier
    ds_read_b128 v[24:27], v84 offset:8192
    ds_read_b128 v[28:31], v84 offset:9216
    s_waitcnt lgkmcnt(0)
    s_branch P1_SOFTMAX
P1_CONS:
    s_and_b32 s60, s24, 1
    s_lshr_b32 s61, s24, 1
    v_mov_b32 v220, 0
    v_mov_b32 v221, 0
    v_mov_b32 v222, 0
    v_mov_b32 v223, 0
    v_mov_b32 v224, 2048
    ds_write_b128 v224, v[220:223]
    ds_write_b32 v224, v220 offset:16
    s_waitcnt lgkmcnt(0)
    s_mov_b32 s28, s22
    s_and_b32 s29, s23, 0xffff
    s_mov_b32 s30, 268435456
    s_mov_b32 s31, 0x20000
    s_mov_b32 s52, s20
    s_and_b32 s53, s21, 0xffff
    s_mov_b32 s54, 256
    s_mov_b32 s55, 0x20000
    s_barrier
    v_mov_b32 v226, 8323072
    buffer_load_dword v227, v226, s[28:31], 0 offen sc1
    s_cmp_eq_u32 s24, 0
    s_cbranch_scc0 P1_NOTK
    s_lshl_b32 s46, s57, 2
    v_mov_b32 v224, s46
    v_mov_b32 v225, 1
    v_cmp_eq_u32 vcc, 0, v0
    s_and_saveexec_b64 s[48:49], vcc
    buffer_atomic_add v225, v224, s[52:55], 0 offen sc0
    s_mov_b64 exec, s[48:49]
P1_NOTK:
    s_waitcnt vmcnt(8)
    v_lshlrev_b32 v144, 16, v80
    v_and_b32 v145, 0xffff0000, v80
    v_pk_mul_f32 v[210:211], v[144:145], v[144:145]
    v_mov_b32 v208, v144
    v_mov_b32 v209, v145
    v_lshlrev_b32 v146, 16, v81
    v_and_b32 v147, 0xffff0000, v81
    v_pk_add_f32 v[208:209], v[208:209], v[146:147]
    v_pk_fma_f32 v[210:211], v[146:147], v[146:147], v[210:211]
    v_lshlrev_b32 v148, 16, v82
    v_and_b32 v149, 0xffff0000, v82
    v_pk_add_f32 v[208:209], v[208:209], v[148:149]
    v_pk_fma_f32 v[210:211], v[148:149], v[148:149], v[210:211]
    v_lshlrev_b32 v150, 16, v83
    v_and_b32 v151, 0xffff0000, v83
    v_pk_add_f32 v[208:209], v[208:209], v[150:151]
    v_pk_fma_f32 v[210:211], v[150:151], v[150:151], v[210:211]
    v_lshlrev_b32 v152, 16, v84
    v_and_b32 v153, 0xffff0000, v84
    v_pk_add_f32 v[208:209], v[208:209], v[152:153]
    v_pk_fma_f32 v[210:211], v[152:153], v[152:153], v[210:211]
    v_lshlrev_b32 v154, 16, v85
    v_and_b32 v155, 0xffff0000, v85
    v_pk_add_f32 v[208:209], v[208:209], v[154:155]
    v_pk_fma_f32 v[210:211], v[154:155], v[154:155], v[210:211]
    v_lshlrev_b32 v156, 16, v86
    v_and_b32 v157, 0xffff0000, v86
    v_pk_add_f32 v[208:209], v[208:209], v[156:157]
    v_pk_fma_f32 v[210:211], v[156:157], v[156:157], v[210:211]
    v_lshlrev_b32 v158, 16, v87
    v_and_b32 v159, 0xffff0000, v87
    v_pk_add_f32 v[208:209], v[208:209], v[158:159]
    v_pk_fma_f32 v[210:211], v[158:159], v[158:159], v[210:211]
    v_lshlrev_b32 v160, 16, v88
    v_and_b32 v161, 0xffff0000, v88
    v_pk_add_f32 v[208:209], v[208:209], v[160:161]
    v_pk_fma_f32 v[210:211], v[160:161], v[160:161], v[210:211]
    v_lshlrev_b32 v162, 16, v89
    v_and_b32 v163, 0xffff0000, v89
    v_pk_add_f32 v[208:209], v[208:209], v[162:163]
    v_pk_fma_f32 v[210:211], v[162:163], v[162:163], v[210:211]
    v_lshlrev_b32 v164, 16, v90
    v_and_b32 v165, 0xffff0000, v90
    v_pk_add_f32 v[208:209], v[208:209], v[164:165]
    v_pk_fma_f32 v[210:211], v[164:165], v[164:165], v[210:211]
    v_lshlrev_b32 v166, 16, v91
    v_and_b32 v167, 0xffff0000, v91
    v_pk_add_f32 v[208:209], v[208:209], v[166:167]
    v_pk_fma_f32 v[210:211], v[166:167], v[166:167], v[210:211]
    v_lshlrev_b32 v168, 16, v92
    v_and_b32 v169, 0xffff0000, v92
    v_pk_add_f32 v[208:209], v[208:209], v[168:169]
    v_pk_fma_f32 v[210:211], v[168:169], v[168:169], v[210:211]
    v_lshlrev_b32 v170, 16, v93
    v_and_b32 v171, 0xffff0000, v93
    v_pk_add_f32 v[208:209], v[208:209], v[170:171]
    v_pk_fma_f32 v[210:211], v[170:171], v[170:171], v[210:211]
    v_lshlrev_b32 v172, 16, v94
    v_and_b32 v173, 0xffff0000, v94
    v_pk_add_f32 v[208:209], v[208:209], v[172:173]
    v_pk_fma_f32 v[210:211], v[172:173], v[172:173], v[210:211]
    v_lshlrev_b32 v174, 16, v95
    v_and_b32 v175, 0xffff0000, v95
    v_pk_add_f32 v[208:209], v[208:209], v[174:175]
    v_pk_fma_f32 v[210:211], v[174:175], v[174:175], v[210:211]
    v_lshlrev_b32 v176, 16, v96
    v_and_b32 v177, 0xffff0000, v96
    v_pk_add_f32 v[208:209], v[208:209], v[176:177]
    v_pk_fma_f32 v[210:211], v[176:177], v[176:177], v[210:211]
    v_lshlrev_b32 v178, 16, v97
    v_and_b32 v179, 0xffff0000, v97
    v_pk_add_f32 v[208:209], v[208:209], v[178:179]
    v_pk_fma_f32 v[210:211], v[178:179], v[178:179], v[210:211]
    v_lshlrev_b32 v180, 16, v98
    v_and_b32 v181, 0xffff0000, v98
    v_pk_add_f32 v[208:209], v[208:209], v[180:181]
    v_pk_fma_f32 v[210:211], v[180:181], v[180:181], v[210:211]
    v_lshlrev_b32 v182, 16, v99
    v_and_b32 v183, 0xffff0000, v99
    v_pk_add_f32 v[208:209], v[208:209], v[182:183]
    v_pk_fma_f32 v[210:211], v[182:183], v[182:183], v[210:211]
    v_lshlrev_b32 v184, 16, v100
    v_and_b32 v185, 0xffff0000, v100
    v_pk_add_f32 v[208:209], v[208:209], v[184:185]
    v_pk_fma_f32 v[210:211], v[184:185], v[184:185], v[210:211]
    v_lshlrev_b32 v186, 16, v101
    v_and_b32 v187, 0xffff0000, v101
    v_pk_add_f32 v[208:209], v[208:209], v[186:187]
    v_pk_fma_f32 v[210:211], v[186:187], v[186:187], v[210:211]
    v_lshlrev_b32 v188, 16, v102
    v_and_b32 v189, 0xffff0000, v102
    v_pk_add_f32 v[208:209], v[208:209], v[188:189]
    v_pk_fma_f32 v[210:211], v[188:189], v[188:189], v[210:211]
    v_lshlrev_b32 v190, 16, v103
    v_and_b32 v191, 0xffff0000, v103
    v_pk_add_f32 v[208:209], v[208:209], v[190:191]
    v_pk_fma_f32 v[210:211], v[190:191], v[190:191], v[210:211]
    v_lshlrev_b32 v192, 16, v104
    v_and_b32 v193, 0xffff0000, v104
    v_pk_add_f32 v[208:209], v[208:209], v[192:193]
    v_pk_fma_f32 v[210:211], v[192:193], v[192:193], v[210:211]
    v_lshlrev_b32 v194, 16, v105
    v_and_b32 v195, 0xffff0000, v105
    v_pk_add_f32 v[208:209], v[208:209], v[194:195]
    v_pk_fma_f32 v[210:211], v[194:195], v[194:195], v[210:211]
    v_lshlrev_b32 v196, 16, v106
    v_and_b32 v197, 0xffff0000, v106
    v_pk_add_f32 v[208:209], v[208:209], v[196:197]
    v_pk_fma_f32 v[210:211], v[196:197], v[196:197], v[210:211]
    v_lshlrev_b32 v198, 16, v107
    v_and_b32 v199, 0xffff0000, v107
    v_pk_add_f32 v[208:209], v[208:209], v[198:199]
    v_pk_fma_f32 v[210:211], v[198:199], v[198:199], v[210:211]
    v_lshlrev_b32 v200, 16, v108
    v_and_b32 v201, 0xffff0000, v108
    v_pk_add_f32 v[208:209], v[208:209], v[200:201]
    v_pk_fma_f32 v[210:211], v[200:201], v[200:201], v[210:211]
    v_lshlrev_b32 v202, 16, v109
    v_and_b32 v203, 0xffff0000, v109
    v_pk_add_f32 v[208:209], v[208:209], v[202:203]
    v_pk_fma_f32 v[210:211], v[202:203], v[202:203], v[210:211]
    v_lshlrev_b32 v204, 16, v110
    v_and_b32 v205, 0xffff0000, v110
    v_pk_add_f32 v[208:209], v[208:209], v[204:205]
    v_pk_fma_f32 v[210:211], v[204:205], v[204:205], v[210:211]
    v_lshlrev_b32 v206, 16, v111
    v_and_b32 v207, 0xffff0000, v111
    v_pk_add_f32 v[208:209], v[208:209], v[206:207]
    v_pk_fma_f32 v[210:211], v[206:207], v[206:207], v[210:211]
    v_add_f32 v208, v208, v209
    v_add_f32 v210, v210, v211
    s_nop 1
    v_add_f32_dpp v208, v208, v208 quad_perm:[1,0,3,2] row_mask:0xf bank_mask:0xf
    v_add_f32_dpp v210, v210, v210 quad_perm:[1,0,3,2] row_mask:0xf bank_mask:0xf
    s_nop 1
    v_add_f32_dpp v208, v208, v208 quad_perm:[2,3,0,1] row_mask:0xf bank_mask:0xf
    v_add_f32_dpp v210, v210, v210 quad_perm:[2,3,0,1] row_mask:0xf bank_mask:0xf
    s_nop 1
    v_add_f32_dpp v208, v208, v208 row_half_mirror row_mask:0xf bank_mask:0xf
    v_add_f32_dpp v210, v210, v210 row_half_mirror row_mask:0xf bank_mask:0xf
    v_mul_f32 v208, 0x3b000000, v208
    v_mul_f32 v210, 0x3b000000, v210
    v_fma_f32 v210, -v208, v208, v210
    v_max_f32 v210, 0, v210
    v_add_f32 v210, 0x3727c5ac, v210
    v_rsq_f32 v210, v210
    s_nop 0
    v_lshrrev_b32 v212, 4, v0
    v_add_u32 v212, 0, v212
    v_mul_f32 v208, v208, v210
    v_sub_f32 v208, 0, v208
    v_xor_b32 v212, v212, v0
    v_and_b32 v212, 7, v212
    v_lshrrev_b32 v213, 3, v0
    v_lshlrev_b32 v213, 7, v213
    v_lshl_add_u32 v212, v212, 4, v213
    s_lshl_b32 s44, s25, 11
    s_add_u32 s44, s44, 8192
    v_add_u32 v212, s44, v212
    v_pk_fma_f32 v[144:145], v[144:145], v[210:211], v[208:209] op_sel_hi:[1,0,0]
    v_cvt_pk_bf16_f32 v80, v144, v145
    v_pk_fma_f32 v[146:147], v[146:147], v[210:211], v[208:209] op_sel_hi:[1,0,0]
    v_cvt_pk_bf16_f32 v81, v146, v147
    v_pk_fma_f32 v[148:149], v[148:149], v[210:211], v[208:209] op_sel_hi:[1,0,0]
    v_cvt_pk_bf16_f32 v82, v148, v149
    v_pk_fma_f32 v[150:151], v[150:151], v[210:211], v[208:209] op_sel_hi:[1,0,0]
    v_cvt_pk_bf16_f32 v83, v150, v151
    ds_write_b128 v212, v[80:83] offset:0
    v_pk_fma_f32 v[152:153], v[152:153], v[210:211], v[208:209] op_sel_hi:[1,0,0]
    v_cvt_pk_bf16_f32 v84, v152, v153
    v_pk_fma_f32 v[154:155], v[154:155], v[210:211], v[208:209] op_sel_hi:[1,0,0]
    v_cvt_pk_bf16_f32 v85, v154, v155
    v_pk_fma_f32 v[156:157], v[156:157], v[210:211], v[208:209] op_sel_hi:[1,0,0]
    v_cvt_pk_bf16_f32 v86, v156, v157
    v_pk_fma_f32 v[158:159], v[158:159], v[210:211], v[208:209] op_sel_hi:[1,0,0]
    v_cvt_pk_bf16_f32 v87, v158, v159
    ds_write_b128 v212, v[84:87] offset:8192
    v_pk_fma_f32 v[160:161], v[160:161], v[210:211], v[208:209] op_sel_hi:[1,0,0]
    v_cvt_pk_bf16_f32 v88, v160, v161
    v_pk_fma_f32 v[162:163], v[162:163], v[210:211], v[208:209] op_sel_hi:[1,0,0]
    v_cvt_pk_bf16_f32 v89, v162, v163
    v_pk_fma_f32 v[164:165], v[164:165], v[210:211], v[208:209] op_sel_hi:[1,0,0]
    v_cvt_pk_bf16_f32 v90, v164, v165
    v_pk_fma_f32 v[166:167], v[166:167], v[210:211], v[208:209] op_sel_hi:[1,0,0]
    v_cvt_pk_bf16_f32 v91, v166, v167
    ds_write_b128 v212, v[88:91] offset:16384
    v_pk_fma_f32 v[168:169], v[168:169], v[210:211], v[208:209] op_sel_hi:[1,0,0]
    v_cvt_pk_bf16_f32 v92, v168, v169
    v_pk_fma_f32 v[170:171], v[170:171], v[210:211], v[208:209] op_sel_hi:[1,0,0]
    v_cvt_pk_bf16_f32 v93, v170, v171
    v_pk_fma_f32 v[172:173], v[172:173], v[210:211], v[208:209] op_sel_hi:[1,0,0]
    v_cvt_pk_bf16_f32 v94, v172, v173
    v_pk_fma_f32 v[174:175], v[174:175], v[210:211], v[208:209] op_sel_hi:[1,0,0]
    v_cvt_pk_bf16_f32 v95, v174, v175
    ds_write_b128 v212, v[92:95] offset:24576
    v_pk_fma_f32 v[176:177], v[176:177], v[210:211], v[208:209] op_sel_hi:[1,0,0]
    v_cvt_pk_bf16_f32 v96, v176, v177
    v_pk_fma_f32 v[178:179], v[178:179], v[210:211], v[208:209] op_sel_hi:[1,0,0]
    v_cvt_pk_bf16_f32 v97, v178, v179
    v_pk_fma_f32 v[180:181], v[180:181], v[210:211], v[208:209] op_sel_hi:[1,0,0]
    v_cvt_pk_bf16_f32 v98, v180, v181
    v_pk_fma_f32 v[182:183], v[182:183], v[210:211], v[208:209] op_sel_hi:[1,0,0]
    v_cvt_pk_bf16_f32 v99, v182, v183
    ds_write_b128 v212, v[96:99] offset:32768
    v_pk_fma_f32 v[184:185], v[184:185], v[210:211], v[208:209] op_sel_hi:[1,0,0]
    v_cvt_pk_bf16_f32 v100, v184, v185
    v_pk_fma_f32 v[186:187], v[186:187], v[210:211], v[208:209] op_sel_hi:[1,0,0]
    v_cvt_pk_bf16_f32 v101, v186, v187
    v_pk_fma_f32 v[188:189], v[188:189], v[210:211], v[208:209] op_sel_hi:[1,0,0]
    v_cvt_pk_bf16_f32 v102, v188, v189
    v_pk_fma_f32 v[190:191], v[190:191], v[210:211], v[208:209] op_sel_hi:[1,0,0]
    v_cvt_pk_bf16_f32 v103, v190, v191
    ds_write_b128 v212, v[100:103] offset:40960
    v_pk_fma_f32 v[192:193], v[192:193], v[210:211], v[208:209] op_sel_hi:[1,0,0]
    v_cvt_pk_bf16_f32 v104, v192, v193
    v_pk_fma_f32 v[194:195], v[194:195], v[210:211], v[208:209] op_sel_hi:[1,0,0]
    v_cvt_pk_bf16_f32 v105, v194, v195
    v_pk_fma_f32 v[196:197], v[196:197], v[210:211], v[208:209] op_sel_hi:[1,0,0]
    v_cvt_pk_bf16_f32 v106, v196, v197
    v_pk_fma_f32 v[198:199], v[198:199], v[210:211], v[208:209] op_sel_hi:[1,0,0]
    v_cvt_pk_bf16_f32 v107, v198, v199
    ds_write_b128 v212, v[104:107] offset:49152
    v_pk_fma_f32 v[200:201], v[200:201], v[210:211], v[208:209] op_sel_hi:[1,0,0]
    v_cvt_pk_bf16_f32 v108, v200, v201
    v_pk_fma_f32 v[202:203], v[202:203], v[210:211], v[208:209] op_sel_hi:[1,0,0]
    v_cvt_pk_bf16_f32 v109, v202, v203
    v_pk_fma_f32 v[204:205], v[204:205], v[210:211], v[208:209] op_sel_hi:[1,0,0]
    v_cvt_pk_bf16_f32 v110, v204, v205
    v_pk_fma_f32 v[206:207], v[206:207], v[210:211], v[208:209] op_sel_hi:[1,0,0]
    v_cvt_pk_bf16_f32 v111, v206, v207
    ds_write_b128 v212, v[108:111] offset:57344
    s_cmp_eq_u32 s24, 0
    s_cbranch_scc1 P1_W0
    s_waitcnt vmcnt(1)
    s_branch P1_W2
P1_W0:
    s_waitcnt vmcnt(2)
P1_W2:
    v_lshlrev_b32 v144, 16, v112
    v_and_b32 v145, 0xffff0000, v112
    v_pk_mul_f32 v[210:211], v[144:145], v[144:145]
    v_mov_b32 v208, v144
    v_mov_b32 v209, v145
    v_lshlrev_b32 v146, 16, v113
    v_and_b32 v147, 0xffff0000, v113
    v_pk_add_f32 v[208:209], v[208:209], v[146:147]
    v_pk_fma_f32 v[210:211], v[146:147], v[146:147], v[210:211]
    v_lshlrev_b32 v148, 16, v114
    v_and_b32 v149, 0xffff0000, v114
    v_pk_add_f32 v[208:209], v[208:209], v[148:149]
    v_pk_fma_f32 v[210:211], v[148:149], v[148:149], v[210:211]
    v_lshlrev_b32 v150, 16, v115
    v_and_b32 v151, 0xffff0000, v115
    v_pk_add_f32 v[208:209], v[208:209], v[150:151]
    v_pk_fma_f32 v[210:211], v[150:151], v[150:151], v[210:211]
    v_lshlrev_b32 v152, 16, v116
    v_and_b32 v153, 0xffff0000, v116
    v_pk_add_f32 v[208:209], v[208:209], v[152:153]
    v_pk_fma_f32 v[210:211], v[152:153], v[152:153], v[210:211]
    v_lshlrev_b32 v154, 16, v117
    v_and_b32 v155, 0xffff0000, v117
    v_pk_add_f32 v[208:209], v[208:209], v[154:155]
    v_pk_fma_f32 v[210:211], v[154:155], v[154:155], v[210:211]
    v_lshlrev_b32 v156, 16, v118
    v_and_b32 v157, 0xffff0000, v118
    v_pk_add_f32 v[208:209], v[208:209], v[156:157]
    v_pk_fma_f32 v[210:211], v[156:157], v[156:157], v[210:211]
    v_lshlrev_b32 v158, 16, v119
    v_and_b32 v159, 0xffff0000, v119
    v_pk_add_f32 v[208:209], v[208:209], v[158:159]
    v_pk_fma_f32 v[210:211], v[158:159], v[158:159], v[210:211]
    v_lshlrev_b32 v160, 16, v120
    v_and_b32 v161, 0xffff0000, v120
    v_pk_add_f32 v[208:209], v[208:209], v[160:161]
    v_pk_fma_f32 v[210:211], v[160:161], v[160:161], v[210:211]
    v_lshlrev_b32 v162, 16, v121
    v_and_b32 v163, 0xffff0000, v121
    v_pk_add_f32 v[208:209], v[208:209], v[162:163]
    v_pk_fma_f32 v[210:211], v[162:163], v[162:163], v[210:211]
    v_lshlrev_b32 v164, 16, v122
    v_and_b32 v165, 0xffff0000, v122
    v_pk_add_f32 v[208:209], v[208:209], v[164:165]
    v_pk_fma_f32 v[210:211], v[164:165], v[164:165], v[210:211]
    v_lshlrev_b32 v166, 16, v123
    v_and_b32 v167, 0xffff0000, v123
    v_pk_add_f32 v[208:209], v[208:209], v[166:167]
    v_pk_fma_f32 v[210:211], v[166:167], v[166:167], v[210:211]
    v_lshlrev_b32 v168, 16, v124
    v_and_b32 v169, 0xffff0000, v124
    v_pk_add_f32 v[208:209], v[208:209], v[168:169]
    v_pk_fma_f32 v[210:211], v[168:169], v[168:169], v[210:211]
    v_lshlrev_b32 v170, 16, v125
    v_and_b32 v171, 0xffff0000, v125
    v_pk_add_f32 v[208:209], v[208:209], v[170:171]
    v_pk_fma_f32 v[210:211], v[170:171], v[170:171], v[210:211]
    v_lshlrev_b32 v172, 16, v126
    v_and_b32 v173, 0xffff0000, v126
    v_pk_add_f32 v[208:209], v[208:209], v[172:173]
    v_pk_fma_f32 v[210:211], v[172:173], v[172:173], v[210:211]
    v_lshlrev_b32 v174, 16, v127
    v_and_b32 v175, 0xffff0000, v127
    v_pk_add_f32 v[208:209], v[208:209], v[174:175]
    v_pk_fma_f32 v[210:211], v[174:175], v[174:175], v[210:211]
    v_lshlrev_b32 v176, 16, v128
    v_and_b32 v177, 0xffff0000, v128
    v_pk_add_f32 v[208:209], v[208:209], v[176:177]
    v_pk_fma_f32 v[210:211], v[176:177], v[176:177], v[210:211]
    v_lshlrev_b32 v178, 16, v129
    v_and_b32 v179, 0xffff0000, v129
    v_pk_add_f32 v[208:209], v[208:209], v[178:179]
    v_pk_fma_f32 v[210:211], v[178:179], v[178:179], v[210:211]
    v_lshlrev_b32 v180, 16, v130
    v_and_b32 v181, 0xffff0000, v130
    v_pk_add_f32 v[208:209], v[208:209], v[180:181]
    v_pk_fma_f32 v[210:211], v[180:181], v[180:181], v[210:211]
    v_lshlrev_b32 v182, 16, v131
    v_and_b32 v183, 0xffff0000, v131
    v_pk_add_f32 v[208:209], v[208:209], v[182:183]
    v_pk_fma_f32 v[210:211], v[182:183], v[182:183], v[210:211]
    v_lshlrev_b32 v184, 16, v132
    v_and_b32 v185, 0xffff0000, v132
    v_pk_add_f32 v[208:209], v[208:209], v[184:185]
    v_pk_fma_f32 v[210:211], v[184:185], v[184:185], v[210:211]
    v_lshlrev_b32 v186, 16, v133
    v_and_b32 v187, 0xffff0000, v133
    v_pk_add_f32 v[208:209], v[208:209], v[186:187]
    v_pk_fma_f32 v[210:211], v[186:187], v[186:187], v[210:211]
    v_lshlrev_b32 v188, 16, v134
    v_and_b32 v189, 0xffff0000, v134
    v_pk_add_f32 v[208:209], v[208:209], v[188:189]
    v_pk_fma_f32 v[210:211], v[188:189], v[188:189], v[210:211]
    v_lshlrev_b32 v190, 16, v135
    v_and_b32 v191, 0xffff0000, v135
    v_pk_add_f32 v[208:209], v[208:209], v[190:191]
    v_pk_fma_f32 v[210:211], v[190:191], v[190:191], v[210:211]
    v_lshlrev_b32 v192, 16, v136
    v_and_b32 v193, 0xffff0000, v136
    v_pk_add_f32 v[208:209], v[208:209], v[192:193]
    v_pk_fma_f32 v[210:211], v[192:193], v[192:193], v[210:211]
    v_lshlrev_b32 v194, 16, v137
    v_and_b32 v195, 0xffff0000, v137
    v_pk_add_f32 v[208:209], v[208:209], v[194:195]
    v_pk_fma_f32 v[210:211], v[194:195], v[194:195], v[210:211]
    v_lshlrev_b32 v196, 16, v138
    v_and_b32 v197, 0xffff0000, v138
    v_pk_add_f32 v[208:209], v[208:209], v[196:197]
    v_pk_fma_f32 v[210:211], v[196:197], v[196:197], v[210:211]
    v_lshlrev_b32 v198, 16, v139
    v_and_b32 v199, 0xffff0000, v139
    v_pk_add_f32 v[208:209], v[208:209], v[198:199]
    v_pk_fma_f32 v[210:211], v[198:199], v[198:199], v[210:211]
    v_lshlrev_b32 v200, 16, v140
    v_and_b32 v201, 0xffff0000, v140
    v_pk_add_f32 v[208:209], v[208:209], v[200:201]
    v_pk_fma_f32 v[210:211], v[200:201], v[200:201], v[210:211]
    v_lshlrev_b32 v202, 16, v141
    v_and_b32 v203, 0xffff0000, v141
    v_pk_add_f32 v[208:209], v[208:209], v[202:203]
    v_pk_fma_f32 v[210:211], v[202:203], v[202:203], v[210:211]
    v_lshlrev_b32 v204, 16, v142
    v_and_b32 v205, 0xffff0000, v142
    v_pk_add_f32 v[208:209], v[208:209], v[204:205]
    v_pk_fma_f32 v[210:211], v[204:205], v[204:205], v[210:211]
    v_lshlrev_b32 v206, 16, v143
    v_and_b32 v207, 0xffff0000, v143
    v_pk_add_f32 v[208:209], v[208:209], v[206:207]
    v_pk_fma_f32 v[210:211], v[206:207], v[206:207], v[210:211]
    v_add_f32 v208, v208, v209
    v_add_f32 v210, v210, v211
    s_nop 1
    v_add_f32_dpp v208, v208, v208 quad_perm:[1,0,3,2] row_mask:0xf bank_mask:0xf
    v_add_f32_dpp v210, v210, v210 quad_perm:[1,0,3,2] row_mask:0xf bank_mask:0xf
    s_nop 1
    v_add_f32_dpp v208, v208, v208 quad_perm:[2,3,0,1] row_mask:0xf bank_mask:0xf
    v_add_f32_dpp v210, v210, v210 quad_perm:[2,3,0,1] row_mask:0xf bank_mask:0xf
    s_nop 1
    v_add_f32_dpp v208, v208, v208 row_half_mirror row_mask:0xf bank_mask:0xf
    v_add_f32_dpp v210, v210, v210 row_half_mirror row_mask:0xf bank_mask:0xf
    v_mul_f32 v208, 0x3b000000, v208
    v_mul_f32 v210, 0x3b000000, v210
    v_fma_f32 v210, -v208, v208, v210
    v_max_f32 v210, 0, v210
    v_add_f32 v210, 0x3727c5ac, v210
    v_rsq_f32 v210, v210
    s_nop 0
    v_lshrrev_b32 v212, 4, v0
    v_add_u32 v212, 4, v212
    v_mul_f32 v208, v208, v210
    v_sub_f32 v208, 0, v208
    v_xor_b32 v212, v212, v0
    v_and_b32 v212, 7, v212
    v_lshrrev_b32 v213, 3, v0
    v_lshlrev_b32 v213, 7, v213
    v_lshl_add_u32 v212, v212, 4, v213
    s_lshl_b32 s44, s25, 11
    s_add_u32 s44, s44, 9216
    v_add_u32 v212, s44, v212
    v_pk_fma_f32 v[144:145], v[144:145], v[210:211], v[208:209] op_sel_hi:[1,0,0]
    v_cvt_pk_bf16_f32 v112, v144, v145
    v_pk_fma_f32 v[146:147], v[146:147], v[210:211], v[208:209] op_sel_hi:[1,0,0]
    v_cvt_pk_bf16_f32 v113, v146, v147
    v_pk_fma_f32 v[148:149], v[148:149], v[210:211], v[208:209] op_sel_hi:[1,0,0]
    v_cvt_pk_bf16_f32 v114, v148, v149
    v_pk_fma_f32 v[150:151], v[150:151], v[210:211], v[208:209] op_sel_hi:[1,0,0]
    v_cvt_pk_bf16_f32 v115, v150, v151
    ds_write_b128 v212, v[112:115] offset:0
    v_pk_fma_f32 v[152:153], v[152:153], v[210:211], v[208:209] op_sel_hi:[1,0,0]
    v_cvt_pk_bf16_f32 v116, v152, v153
    v_pk_fma_f32 v[154:155], v[154:155], v[210:211], v[208:209] op_sel_hi:[1,0,0]
    v_cvt_pk_bf16_f32 v117, v154, v155
    v_pk_fma_f32 v[156:157], v[156:157], v[210:211], v[208:209] op_sel_hi:[1,0,0]
    v_cvt_pk_bf16_f32 v118, v156, v157
    v_pk_fma_f32 v[158:159], v[158:159], v[210:211], v[208:209] op_sel_hi:[1,0,0]
    v_cvt_pk_bf16_f32 v119, v158, v159
    ds_write_b128 v212, v[116:119] offset:8192
    v_pk_fma_f32 v[160:161], v[160:161], v[210:211], v[208:209] op_sel_hi:[1,0,0]
    v_cvt_pk_bf16_f32 v120, v160, v161
    v_pk_fma_f32 v[162:163], v[162:163], v[210:211], v[208:209] op_sel_hi:[1,0,0]
    v_cvt_pk_bf16_f32 v121, v162, v163
    v_pk_fma_f32 v[164:165], v[164:165], v[210:211], v[208:209] op_sel_hi:[1,0,0]
    v_cvt_pk_bf16_f32 v122, v164, v165
    v_pk_fma_f32 v[166:167], v[166:167], v[210:211], v[208:209] op_sel_hi:[1,0,0]
    v_cvt_pk_bf16_f32 v123, v166, v167
    ds_write_b128 v212, v[120:123] offset:16384
    v_pk_fma_f32 v[168:169], v[168:169], v[210:211], v[208:209] op_sel_hi:[1,0,0]
    v_cvt_pk_bf16_f32 v124, v168, v169
    v_pk_fma_f32 v[170:171], v[170:171], v[210:211], v[208:209] op_sel_hi:[1,0,0]
    v_cvt_pk_bf16_f32 v125, v170, v171
    v_pk_fma_f32 v[172:173], v[172:173], v[210:211], v[208:209] op_sel_hi:[1,0,0]
    v_cvt_pk_bf16_f32 v126, v172, v173
    v_pk_fma_f32 v[174:175], v[174:175], v[210:211], v[208:209] op_sel_hi:[1,0,0]
    v_cvt_pk_bf16_f32 v127, v174, v175
    ds_write_b128 v212, v[124:127] offset:24576
    v_pk_fma_f32 v[176:177], v[176:177], v[210:211], v[208:209] op_sel_hi:[1,0,0]
    v_cvt_pk_bf16_f32 v128, v176, v177
    v_pk_fma_f32 v[178:179], v[178:179], v[210:211], v[208:209] op_sel_hi:[1,0,0]
    v_cvt_pk_bf16_f32 v129, v178, v179
    v_pk_fma_f32 v[180:181], v[180:181], v[210:211], v[208:209] op_sel_hi:[1,0,0]
    v_cvt_pk_bf16_f32 v130, v180, v181
    v_pk_fma_f32 v[182:183], v[182:183], v[210:211], v[208:209] op_sel_hi:[1,0,0]
    v_cvt_pk_bf16_f32 v131, v182, v183
    ds_write_b128 v212, v[128:131] offset:32768
    v_pk_fma_f32 v[184:185], v[184:185], v[210:211], v[208:209] op_sel_hi:[1,0,0]
    v_cvt_pk_bf16_f32 v132, v184, v185
    v_pk_fma_f32 v[186:187], v[186:187], v[210:211], v[208:209] op_sel_hi:[1,0,0]
    v_cvt_pk_bf16_f32 v133, v186, v187
    v_pk_fma_f32 v[188:189], v[188:189], v[210:211], v[208:209] op_sel_hi:[1,0,0]
    v_cvt_pk_bf16_f32 v134, v188, v189
    v_pk_fma_f32 v[190:191], v[190:191], v[210:211], v[208:209] op_sel_hi:[1,0,0]
    v_cvt_pk_bf16_f32 v135, v190, v191
    ds_write_b128 v212, v[132:135] offset:40960
    v_pk_fma_f32 v[192:193], v[192:193], v[210:211], v[208:209] op_sel_hi:[1,0,0]
    v_cvt_pk_bf16_f32 v136, v192, v193
    v_pk_fma_f32 v[194:195], v[194:195], v[210:211], v[208:209] op_sel_hi:[1,0,0]
    v_cvt_pk_bf16_f32 v137, v194, v195
    v_pk_fma_f32 v[196:197], v[196:197], v[210:211], v[208:209] op_sel_hi:[1,0,0]
    v_cvt_pk_bf16_f32 v138, v196, v197
    v_pk_fma_f32 v[198:199], v[198:199], v[210:211], v[208:209] op_sel_hi:[1,0,0]
    v_cvt_pk_bf16_f32 v139, v198, v199
    ds_write_b128 v212, v[136:139] offset:49152
    v_pk_fma_f32 v[200:201], v[200:201], v[210:211], v[208:209] op_sel_hi:[1,0,0]
    v_cvt_pk_bf16_f32 v140, v200, v201
    v_pk_fma_f32 v[202:203], v[202:203], v[210:211], v[208:209] op_sel_hi:[1,0,0]
    v_cvt_pk_bf16_f32 v141, v202, v203
    v_pk_fma_f32 v[204:205], v[204:205], v[210:211], v[208:209] op_sel_hi:[1,0,0]
    v_cvt_pk_bf16_f32 v142, v204, v205
    v_pk_fma_f32 v[206:207], v[206:207], v[210:211], v[208:209] op_sel_hi:[1,0,0]
    v_cvt_pk_bf16_f32 v143, v206, v207
    ds_write_b128 v212, v[140:143] offset:57344
    s_waitcnt vmcnt(0)
    v_readfirstlane_b32 s26, v227
    s_nop 3
    s_add_u32 s26, s26, 1
    s_cmp_eq_u32 s24, 0
    s_cbranch_scc0 P1_NOZERO
    v_readfirstlane_b32 s46, v225
    s_nop 3
    s_cmp_eq_u32 s46, 0
    s_cbranch_scc0 P1_NOZERO
    s_mul_i32 s46, s57, 8704
    s_add_u32 s46, s46, 0
    v_lshlrev_b32 v224, 4, v0
    buffer_store_dwordx4 v[220:223], v224, s[28:31], s46 offen offset:0 sc1
    buffer_store_dwordx4 v[220:223], v224, s[28:31], s46 offen offset:1024 sc1
    buffer_store_dwordx4 v[220:223], v224, s[28:31], s46 offen offset:2048 sc1
    buffer_store_dwordx4 v[220:223], v224, s[28:31], s46 offen offset:3072 sc1
    s_add_u32 s46, s46, 4096
    buffer_store_dwordx4 v[220:223], v224, s[28:31], s46 offen offset:0 sc1
    buffer_store_dwordx4 v[220:223], v224, s[28:31], s46 offen offset:1024 sc1
    buffer_store_dwordx4 v[220:223], v224, s[28:31], s46 offen offset:2048 sc1
    buffer_store_dwordx4 v[220:223], v224, s[28:31], s46 offen offset:3072 sc1
    v_cmp_gt_u32 vcc, 32, v0
    s_and_saveexec_b64 s[48:49], vcc
    s_add_u32 s46, s46, 4096
    buffer_store_dwordx4 v[220:223], v224, s[28:31], s46 offen sc1
    s_mov_b64 exec, s[48:49]
    s_mov_b32 s51, 1
    s_branch P1_ZD
P1_NOZERO:
    s_mov_b32 s51, 0
P1_ZD:
    v_and_b32 v172, 31, v0
    v_lshrrev_b32 v173, 5, v0
    v_lshrrev_b32 v174, 1, v172
    v_and_b32 v174, 7, v174
    v_xor_b32 v173, v173, v174
    v_lshlrev_b32 v172, 7, v172
    v_lshl_add_u32 v132, v173, 4, v172
    s_lshl_b32 s46, s60, 12
    s_add_u32 s46, s46, 8192
    v_add_u32 v132, s46, v132
    v_xor_b32 v133, 32, v132
    v_xor_b32 v134, 64, v132
    v_xor_b32 v135, 96, v132
    s_mov_b32 s50, s58
    s_lshl_b32 s46, s50, 13
    v_add_u32 v128, s46, v132
    v_add_u32 v129, s46, v133
    v_add_u32 v130, s46, v134
    v_add_u32 v131, s46, v135
    s_add_u32 s50, s50, 1
    s_and_b32 s50, s50, 7
    v_lshrrev_b32 v172, 5, v0
    v_lshlrev_b32 v172, 3, v172
    v_bfe_u32 v173, v0, 2, 2
    v_add_u32 v172, v172, v173
    v_mul_u32_u24 v172, 384, v172
    v_bfe_u32 v173, v0, 3, 1
    v_xor_b32 v173, s61, v173
    v_lshl_add_u32 v172, v173, 6, v172
    v_and_b32 v173, 1, v0
    v_lshl_add_u32 v172, v173, 5, v172
    v_bfe_u32 v173, v0, 1, 1
    v_bfe_u32 v174, v0, 4, 1
    v_lshl_add_u32 v173, v174, 1, v173
    v_lshl_add_u32 v136, v173, 3, v172
    v_add_u32 v136, 73728, v136
    v_mov_b32 v80, 0
    v_mov_b32 v81, 0
    v_mov_b32 v82, 0
    v_mov_b32 v83, 0
    v_mov_b32 v84, 0
    v_mov_b32 v85, 0
    v_mov_b32 v86, 0
    v_mov_b32 v87, 0
    v_mov_b32 v88, 0
    v_mov_b32 v89, 0
    v_mov_b32 v90, 0
    v_mov_b32 v91, 0
    v_mov_b32 v92, 0
    v_mov_b32 v93, 0
    v_mov_b32 v94, 0
    v_mov_b32 v95, 0
    v_mov_b32 v96, 0
    v_mov_b32 v97, 0
    v_mov_b32 v98, 0
    v_mov_b32 v99, 0
    v_mov_b32 v100, 0
    v_mov_b32 v101, 0
    v_mov_b32 v102, 0
    v_mov_b32 v103, 0
    v_mov_b32 v104, 0
    v_mov_b32 v105, 0
    v_mov_b32 v106, 0
    v_mov_b32 v107, 0
    v_mov_b32 v108, 0
    v_mov_b32 v109, 0
    v_mov_b32 v110, 0
    v_mov_b32 v111, 0
    v_mov_b32 v112, 0
    v_mov_b32 v113, 0
    v_mov_b32 v114, 0
    v_mov_b32 v115, 0
    v_mov_b32 v116, 0
    v_mov_b32 v117, 0
    v_mov_b32 v118, 0
    v_mov_b32 v119, 0
    v_mov_b32 v120, 0
    v_mov_b32 v121, 0
    v_mov_b32 v122, 0
    v_mov_b32 v123, 0
    v_mov_b32 v124, 0
    v_mov_b32 v125, 0
    v_mov_b32 v126, 0
    v_mov_b32 v127, 0
    s_waitcnt lgkmcnt(0)
    s_barrier
    ds_read_b128 v[140:143], v128
    ds_read_b64_tr_b16 v[148:149], v136 offset:0
    ds_read_b64_tr_b16 v[150:151], v136 offset:1536
    ds_read_b64_tr_b16 v[152:153], v136 offset:128
    ds_read_b64_tr_b16 v[154:155], v136 offset:1664
    ds_read_b64_tr_b16 v[156:157], v136 offset:256
    ds_read_b64_tr_b16 v[158:159], v136 offset:1792
    v_lshrrev_b32 v4, 5, v0
    v_bfe_u32 v5, v0, 2, 2
    v_lshlrev_b32 v5, 5, v5
    v_lshl_add_u32 v5, v4, 9, v5
    v_bfe_u32 v6, v0, 1, 1
    v_bfe_u32 v7, v0, 4, 1
    v_lshl_add_u32 v6, v7, 1, v6
    v_lshl_add_u32 v5, v6, 3, v5
    s_lshr_b32 s46, s25, 1
    s_lshl_b32 s46, s46, 10
    s_add_u32 s46, s46, 0
    v_add_u32 v5, s46, v5
    v_and_b32 v6, 1, v0
    v_cmp_eq_u32 vcc, v6, v4
    v_mov_b32 v7, 2048
    s_nop 0
    v_add_u32 v6, 0, v5
    v_cndmask_b32 v6, v7, v6, vcc
    ds_read_b64_tr_b16 v[16:17], v6
    v_add_u32 v6, 128, v5
    v_cndmask_b32 v6, v7, v6, vcc
    ds_read_b64_tr_b16 v[18:19], v6
    v_add_u32 v6, 256, v5
    v_cndmask_b32 v6, v7, v6, vcc
    ds_read_b64_tr_b16 v[20:21], v6
    v_add_u32 v6, 384, v5
    v_cndmask_b32 v6, v7, v6, vcc
    ds_read_b64_tr_b16 v[22:23], v6
    s_waitcnt lgkmcnt(8)
    v_mfma_f32_32x32x16_bf16 v[80:95], v[148:151], v[140:143], v[80:95]
    ds_read_b128 v[144:147], v129
    ds_read_b64_tr_b16 v[160:161], v136 offset:6144
    ds_read_b64_tr_b16 v[162:163], v136 offset:7680
    s_waitcnt lgkmcnt(9)
    v_mfma_f32_32x32x16_bf16 v[96:111], v[152:155], v[140:143], v[96:111]
    ds_read_b64_tr_b16 v[164:165], v136 offset:6272
    ds_read_b64_tr_b16 v[166:167], v136 offset:7808
    s_waitcnt lgkmcnt(9)
    v_mfma_f32_32x32x16_bf16 v[112:127], v[156:159], v[140:143], v[112:127]
    ds_read_b64_tr_b16 v[168:169], v136 offset:6400
    ds_read_b64_tr_b16 v[170:171], v136 offset:7936
    s_waitcnt lgkmcnt(4)
    v_mfma_f32_32x32x16_bf16 v[80:95], v[160:163], v[144:147], v[80:95]
    ds_read_b128 v[140:143], v130
    ds_read_b64_tr_b16 v[148:149], v136 offset:12288
    ds_read_b64_tr_b16 v[150:151], v136 offset:13824
    s_waitcnt lgkmcnt(5)
    v_mfma_f32_32x32x16_bf16 v[96:111], v[164:167], v[144:147], v[96:111]
    ds_read_b64_tr_b16 v[152:153], v136 offset:12416
    ds_read_b64_tr_b16 v[154:155], v136 offset:13952
    s_waitcnt lgkmcnt(5)
    v_mfma_f32_32x32x16_bf16 v[112:127], v[168:171], v[144:147], v[112:127]
    ds_read_b64_tr_b16 v[156:157], v136 offset:12544
    ds_read_b64_tr_b16 v[158:159], v136 offset:14080
    s_waitcnt lgkmcnt(4)
    v_mfma_f32_32x32x16_bf16 v[80:95], v[148:151], v[140:143], v[80:95]
    ds_read_b128 v[144:147], v131
    ds_read_b64_tr_b16 v[160:161], v136 offset:18432
    ds_read_b64_tr_b16 v[162:163], v136 offset:19968
    s_waitcnt lgkmcnt(5)
    v_mfma_f32_32x32x16_bf16 v[96:111], v[152:155], v[140:143], v[96:111]
    ds_read_b64_tr_b16 v[164:165], v136 offset:18560
    ds_read_b64_tr_b16 v[166:167], v136 offset:20096
    s_waitcnt lgkmcnt(5)
    v_mfma_f32_32x32x16_bf16 v[112:127], v[156:159], v[140:143], v[112:127]
    ds_read_b64_tr_b16 v[168:169], v136 offset:18688
    ds_read_b64_tr_b16 v[170:171], v136 offset:20224
    s_waitcnt lgkmcnt(4)
    v_mfma_f32_32x32x16_bf16 v[80:95], v[160:163], v[144:147], v[80:95]
    s_waitcnt lgkmcnt(0)
    s_barrier
    v_add_u32 v136, 0x6000, v136
    s_lshl_b32 s46, s50, 13
    v_add_u32 v128, s46, v132
    v_add_u32 v129, s46, v133
    v_add_u32 v130, s46, v134
    v_add_u32 v131, s46, v135
    s_add_u32 s50, s50, 1
    s_and_b32 s50, s50, 7
    ds_read_b128 v[140:143], v128
    ds_read_b64_tr_b16 v[148:149], v136 offset:0
    ds_read_b64_tr_b16 v[150:151], v136 offset:1536
    v_mfma_f32_32x32x16_bf16 v[96:111], v[164:167], v[144:147], v[96:111]
    ds_read_b64_tr_b16 v[152:153], v136 offset:128
    ds_read_b64_tr_b16 v[154:155], v136 offset:1664
    v_mfma_f32_32x32x16_bf16 v[112:127], v[168:171], v[144:147], v[112:127]
    ds_read_b64_tr_b16 v[156:157], v136 offset:256
    ds_read_b64_tr_b16 v[158:159], v136 offset:1792
    s_waitcnt lgkmcnt(4)
    v_mfma_f32_32x32x16_bf16 v[80:95], v[148:151], v[140:143], v[80:95]
    ds_read_b128 v[144:147], v129
    ds_read_b64_tr_b16 v[160:161], v136 offset:6144
    ds_read_b64_tr_b16 v[162:163], v136 offset:7680
    s_waitcnt lgkmcnt(5)
    v_mfma_f32_32x32x16_bf16 v[96:111], v[152:155], v[140:143], v[96:111]
    ds_read_b64_tr_b16 v[164:165], v136 offset:6272
    ds_read_b64_tr_b16 v[166:167], v136 offset:7808
    s_waitcnt lgkmcnt(5)
    v_mfma_f32_32x32x16_bf16 v[112:127], v[156:159], v[140:143], v[112:127]
    ds_read_b64_tr_b16 v[168:169], v136 offset:6400
    ds_read_b64_tr_b16 v[170:171], v136 offset:7936
    s_waitcnt lgkmcnt(4)
    v_mfma_f32_32x32x16_bf16 v[80:95], v[160:163], v[144:147], v[80:95]
    ds_read_b128 v[140:143], v130
    ds_read_b64_tr_b16 v[148:149], v136 offset:12288
    ds_read_b64_tr_b16 v[150:151], v136 offset:13824
    s_waitcnt lgkmcnt(5)
    v_mfma_f32_32x32x16_bf16 v[96:111], v[164:167], v[144:147], v[96:111]
    ds_read_b64_tr_b16 v[152:153], v136 offset:12416
    ds_read_b64_tr_b16 v[154:155], v136 offset:13952
    s_waitcnt lgkmcnt(5)
    v_mfma_f32_32x32x16_bf16 v[112:127], v[168:171], v[144:147], v[112:127]
    ds_read_b64_tr_b16 v[156:157], v136 offset:12544
    ds_read_b64_tr_b16 v[158:159], v136 offset:14080
    s_waitcnt lgkmcnt(4)
    v_mfma_f32_32x32x16_bf16 v[80:95], v[148:151], v[140:143], v[80:95]
    ds_read_b128 v[144:147], v131
    ds_read_b64_tr_b16 v[160:161], v136 offset:18432
    ds_read_b64_tr_b16 v[162:163], v136 offset:19968
    s_waitcnt lgkmcnt(5)
    v_mfma_f32_32x32x16_bf16 v[96:111], v[152:155], v[140:143], v[96:111]
    ds_read_b64_tr_b16 v[164:165], v136 offset:18560
    ds_read_b64_tr_b16 v[166:167], v136 offset:20096
    s_waitcnt lgkmcnt(5)
    v_mfma_f32_32x32x16_bf16 v[112:127], v[156:159], v[140:143], v[112:127]
    ds_read_b64_tr_b16 v[168:169], v136 offset:18688
    ds_read_b64_tr_b16 v[170:171], v136 offset:20224
    s_waitcnt lgkmcnt(4)
    v_mfma_f32_32x32x16_bf16 v[80:95], v[160:163], v[144:147], v[80:95]
    s_waitcnt lgkmcnt(0)
    s_barrier
    v_add_u32 v136, 0x6000, v136
    s_lshl_b32 s46, s50, 13
    v_add_u32 v128, s46, v132
    v_add_u32 v129, s46, v133
    v_add_u32 v130, s46, v134
    v_add_u32 v131, s46, v135
    s_add_u32 s50, s50, 1
    s_and_b32 s50, s50, 7
    ds_read_b128 v[140:143], v128
    ds_read_b64_tr_b16 v[148:149], v136 offset:0
    ds_read_b64_tr_b16 v[150:151], v136 offset:1536
    v_mfma_f32_32x32x16_bf16 v[96:111], v[164:167], v[144:147], v[96:111]
    ds_read_b64_tr_b16 v[152:153], v136 offset:128
    ds_read_b64_tr_b16 v[154:155], v136 offset:1664
    v_mfma_f32_32x32x16_bf16 v[112:127], v[168:171], v[144:147], v[112:127]
    ds_read_b64_tr_b16 v[156:157], v136 offset:256
    ds_read_b64_tr_b16 v[158:159], v136 offset:1792
    s_cmp_eq_u32 s51, 1
    s_cbranch_scc0 P1_NOPUB
    s_waitcnt vmcnt(0)
    s_lshl_b32 s46, s57, 2
    v_mov_b32 v180, s46
    v_mov_b32 v181, 1
    v_cmp_eq_u32 vcc, 0, v0
    s_and_saveexec_b64 s[48:49], vcc
    buffer_store_dword v181, v180, s[52:55], 0 offen offset:64 sc1
    s_mov_b64 exec, s[48:49]
P1_NOPUB:
    s_waitcnt lgkmcnt(4)
    v_mfma_f32_32x32x16_bf16 v[80:95], v[148:151], v[140:143], v[80:95]
    ds_read_b128 v[144:147], v129
    ds_read_b64_tr_b16 v[160:161], v136 offset:6144
    ds_read_b64_tr_b16 v[162:163], v136 offset:7680
    s_waitcnt lgkmcnt(5)
    v_mfma_f32_32x32x16_bf16 v[96:111], v[152:155], v[140:143], v[96:111]
    ds_read_b64_tr_b16 v[164:165], v136 offset:6272
    ds_read_b64_tr_b16 v[166:167], v136 offset:7808
    s_waitcnt lgkmcnt(5)
    v_mfma_f32_32x32x16_bf16 v[112:127], v[156:159], v[140:143], v[112:127]
    ds_read_b64_tr_b16 v[168:169], v136 offset:6400
    ds_read_b64_tr_b16 v[170:171], v136 offset:7936
    s_waitcnt lgkmcnt(4)
    v_mfma_f32_32x32x16_bf16 v[80:95], v[160:163], v[144:147], v[80:95]
    ds_read_b128 v[140:143], v130
    ds_read_b64_tr_b16 v[148:149], v136 offset:12288
    ds_read_b64_tr_b16 v[150:151], v136 offset:13824
    s_waitcnt lgkmcnt(5)
    v_mfma_f32_32x32x16_bf16 v[96:111], v[164:167], v[144:147], v[96:111]
    ds_read_b64_tr_b16 v[152:153], v136 offset:12416
    ds_read_b64_tr_b16 v[154:155], v136 offset:13952
    s_waitcnt lgkmcnt(5)
    v_mfma_f32_32x32x16_bf16 v[112:127], v[168:171], v[144:147], v[112:127]
    ds_read_b64_tr_b16 v[156:157], v136 offset:12544
    ds_read_b64_tr_b16 v[158:159], v136 offset:14080
    s_waitcnt lgkmcnt(4)
    v_mfma_f32_32x32x16_bf16 v[80:95], v[148:151], v[140:143], v[80:95]
    ds_read_b128 v[144:147], v131
    ds_read_b64_tr_b16 v[160:161], v136 offset:18432
    ds_read_b64_tr_b16 v[162:163], v136 offset:19968
    s_waitcnt lgkmcnt(5)
    v_mfma_f32_32x32x16_bf16 v[96:111], v[152:155], v[140:143], v[96:111]
    ds_read_b64_tr_b16 v[164:165], v136 offset:18560
    ds_read_b64_tr_b16 v[166:167], v136 offset:20096
    s_waitcnt lgkmcnt(5)
    v_mfma_f32_32x32x16_bf16 v[112:127], v[156:159], v[140:143], v[112:127]
    ds_read_b64_tr_b16 v[168:169], v136 offset:18688
    ds_read_b64_tr_b16 v[170:171], v136 offset:20224
    s_waitcnt lgkmcnt(4)
    v_mfma_f32_32x32x16_bf16 v[80:95], v[160:163], v[144:147], v[80:95]
    s_waitcnt lgkmcnt(0)
    s_barrier
    v_add_u32 v136, 0xffff4000, v136
    s_lshl_b32 s46, s50, 13
    v_add_u32 v128, s46, v132
    v_add_u32 v129, s46, v133
    v_add_u32 v130, s46, v134
    v_add_u32 v131, s46, v135
    s_add_u32 s50, s50, 1
    s_and_b32 s50, s50, 7
    ds_read_b128 v[140:143], v128
    ds_read_b64_tr_b16 v[148:149], v136 offset:0
    ds_read_b64_tr_b16 v[150:151], v136 offset:1536
    v_mfma_f32_32x32x16_bf16 v[96:111], v[164:167], v[144:147], v[96:111]
    ds_read_b64_tr_b16 v[152:153], v136 offset:128
    ds_read_b64_tr_b16 v[154:155], v136 offset:1664
    v_mfma_f32_32x32x16_bf16 v[112:127], v[168:171], v[144:147], v[112:127]
    ds_read_b64_tr_b16 v[156:157], v136 offset:256
    ds_read_b64_tr_b16 v[158:159], v136 offset:1792
    s_waitcnt lgkmcnt(4)
    v_mfma_f32_32x32x16_bf16 v[80:95], v[148:151], v[140:143], v[80:95]
    ds_read_b128 v[144:147], v129
    ds_read_b64_tr_b16 v[160:161], v136 offset:6144
    ds_read_b64_tr_b16 v[162:163], v136 offset:7680
    s_waitcnt lgkmcnt(5)
    v_mfma_f32_32x32x16_bf16 v[96:111], v[152:155], v[140:143], v[96:111]
    ds_read_b64_tr_b16 v[164:165], v136 offset:6272
    ds_read_b64_tr_b16 v[166:167], v136 offset:7808
    s_waitcnt lgkmcnt(5)
    v_mfma_f32_32x32x16_bf16 v[112:127], v[156:159], v[140:143], v[112:127]
    ds_read_b64_tr_b16 v[168:169], v136 offset:6400
    ds_read_b64_tr_b16 v[170:171], v136 offset:7936
    s_waitcnt lgkmcnt(4)
    v_mfma_f32_32x32x16_bf16 v[80:95], v[160:163], v[144:147], v[80:95]
    ds_read_b128 v[140:143], v130
    ds_read_b64_tr_b16 v[148:149], v136 offset:12288
    ds_read_b64_tr_b16 v[150:151], v136 offset:13824
    s_waitcnt lgkmcnt(5)
    v_mfma_f32_32x32x16_bf16 v[96:111], v[164:167], v[144:147], v[96:111]
    ds_read_b64_tr_b16 v[152:153], v136 offset:12416
    ds_read_b64_tr_b16 v[154:155], v136 offset:13952
    s_waitcnt lgkmcnt(5)
    v_mfma_f32_32x32x16_bf16 v[112:127], v[168:171], v[144:147], v[112:127]
    ds_read_b64_tr_b16 v[156:157], v136 offset:12544
    ds_read_b64_tr_b16 v[158:159], v136 offset:14080
    s_waitcnt lgkmcnt(4)
    v_mfma_f32_32x32x16_bf16 v[80:95], v[148:151], v[140:143], v[80:95]
    ds_read_b128 v[144:147], v131
    ds_read_b64_tr_b16 v[160:161], v136 offset:18432
    ds_read_b64_tr_b16 v[162:163], v136 offset:19968
    s_waitcnt lgkmcnt(5)
    v_mfma_f32_32x32x16_bf16 v[96:111], v[152:155], v[140:143], v[96:111]
    ds_read_b64_tr_b16 v[164:165], v136 offset:18560
    ds_read_b64_tr_b16 v[166:167], v136 offset:20096
    s_waitcnt lgkmcnt(5)
    v_mfma_f32_32x32x16_bf16 v[112:127], v[156:159], v[140:143], v[112:127]
    ds_read_b64_tr_b16 v[168:169], v136 offset:18688
    ds_read_b64_tr_b16 v[170:171], v136 offset:20224
    s_waitcnt lgkmcnt(4)
    v_mfma_f32_32x32x16_bf16 v[80:95], v[160:163], v[144:147], v[80:95]
    s_waitcnt lgkmcnt(0)
    s_barrier
    v_add_u32 v136, 0x6000, v136
    s_lshl_b32 s46, s50, 13
    v_add_u32 v128, s46, v132
    v_add_u32 v129, s46, v133
    v_add_u32 v130, s46, v134
    v_add_u32 v131, s46, v135
    s_add_u32 s50, s50, 1
    s_and_b32 s50, s50, 7
    ds_read_b128 v[140:143], v128
    ds_read_b64_tr_b16 v[148:149], v136 offset:0
    ds_read_b64_tr_b16 v[150:151], v136 offset:1536
    v_mfma_f32_32x32x16_bf16 v[96:111], v[164:167], v[144:147], v[96:111]
    ds_read_b64_tr_b16 v[152:153], v136 offset:128
    ds_read_b64_tr_b16 v[154:155], v136 offset:1664
    v_mfma_f32_32x32x16_bf16 v[112:127], v[168:171], v[144:147], v[112:127]
    ds_read_b64_tr_b16 v[156:157], v136 offset:256
    ds_read_b64_tr_b16 v[158:159], v136 offset:1792
    s_waitcnt lgkmcnt(4)
    v_mfma_f32_32x32x16_bf16 v[80:95], v[148:151], v[140:143], v[80:95]
    ds_read_b128 v[144:147], v129
    ds_read_b64_tr_b16 v[160:161], v136 offset:6144
    ds_read_b64_tr_b16 v[162:163], v136 offset:7680
    s_waitcnt lgkmcnt(5)
    v_mfma_f32_32x32x16_bf16 v[96:111], v[152:155], v[140:143], v[96:111]
    ds_read_b64_tr_b16 v[164:165], v136 offset:6272
    ds_read_b64_tr_b16 v[166:167], v136 offset:7808
    s_waitcnt lgkmcnt(5)
    v_mfma_f32_32x32x16_bf16 v[112:127], v[156:159], v[140:143], v[112:127]
    ds_read_b64_tr_b16 v[168:169], v136 offset:6400
    ds_read_b64_tr_b16 v[170:171], v136 offset:7936
    s_waitcnt lgkmcnt(4)
    v_mfma_f32_32x32x16_bf16 v[80:95], v[160:163], v[144:147], v[80:95]
    ds_read_b128 v[140:143], v130
    ds_read_b64_tr_b16 v[148:149], v136 offset:12288
    ds_read_b64_tr_b16 v[150:151], v136 offset:13824
    s_waitcnt lgkmcnt(5)
    v_mfma_f32_32x32x16_bf16 v[96:111], v[164:167], v[144:147], v[96:111]
    ds_read_b64_tr_b16 v[152:153], v136 offset:12416
    ds_read_b64_tr_b16 v[154:155], v136 offset:13952
    s_waitcnt lgkmcnt(5)
    v_mfma_f32_32x32x16_bf16 v[112:127], v[168:171], v[144:147], v[112:127]
    ds_read_b64_tr_b16 v[156:157], v136 offset:12544
    ds_read_b64_tr_b16 v[158:159], v136 offset:14080
    s_waitcnt lgkmcnt(4)
    v_mfma_f32_32x32x16_bf16 v[80:95], v[148:151], v[140:143], v[80:95]
    ds_read_b128 v[144:147], v131
    ds_read_b64_tr_b16 v[160:161], v136 offset:18432
    ds_read_b64_tr_b16 v[162:163], v136 offset:19968
    s_waitcnt lgkmcnt(5)
    v_mfma_f32_32x32x16_bf16 v[96:111], v[152:155], v[140:143], v[96:111]
    ds_read_b64_tr_b16 v[164:165], v136 offset:18560
    ds_read_b64_tr_b16 v[166:167], v136 offset:20096
    s_waitcnt lgkmcnt(5)
    v_mfma_f32_32x32x16_bf16 v[112:127], v[156:159], v[140:143], v[112:127]
    ds_read_b64_tr_b16 v[168:169], v136 offset:18688
    ds_read_b64_tr_b16 v[170:171], v136 offset:20224
    s_waitcnt lgkmcnt(4)
    v_mfma_f32_32x32x16_bf16 v[80:95], v[160:163], v[144:147], v[80:95]
    s_waitcnt lgkmcnt(0)
    s_barrier
    v_add_u32 v136, 0x6000, v136
    s_lshl_b32 s46, s50, 13
    v_add_u32 v128, s46, v132
    v_add_u32 v129, s46, v133
    v_add_u32 v130, s46, v134
    v_add_u32 v131, s46, v135
    s_add_u32 s50, s50, 1
    s_and_b32 s50, s50, 7
    ds_read_b128 v[140:143], v128
    ds_read_b64_tr_b16 v[148:149], v136 offset:0
    ds_read_b64_tr_b16 v[150:151], v136 offset:1536
    v_mfma_f32_32x32x16_bf16 v[96:111], v[164:167], v[144:147], v[96:111]
    ds_read_b64_tr_b16 v[152:153], v136 offset:128
    ds_read_b64_tr_b16 v[154:155], v136 offset:1664
    v_mfma_f32_32x32x16_bf16 v[112:127], v[168:171], v[144:147], v[112:127]
    ds_read_b64_tr_b16 v[156:157], v136 offset:256
    ds_read_b64_tr_b16 v[158:159], v136 offset:1792
    s_waitcnt lgkmcnt(4)
    v_mfma_f32_32x32x16_bf16 v[80:95], v[148:151], v[140:143], v[80:95]
    ds_read_b128 v[144:147], v129
    ds_read_b64_tr_b16 v[160:161], v136 offset:6144
    ds_read_b64_tr_b16 v[162:163], v136 offset:7680
    s_waitcnt lgkmcnt(5)
    v_mfma_f32_32x32x16_bf16 v[96:111], v[152:155], v[140:143], v[96:111]
    ds_read_b64_tr_b16 v[164:165], v136 offset:6272
    ds_read_b64_tr_b16 v[166:167], v136 offset:7808
    s_waitcnt lgkmcnt(5)
    v_mfma_f32_32x32x16_bf16 v[112:127], v[156:159], v[140:143], v[112:127]
    ds_read_b64_tr_b16 v[168:169], v136 offset:6400
    ds_read_b64_tr_b16 v[170:171], v136 offset:7936
    s_waitcnt lgkmcnt(4)
    v_mfma_f32_32x32x16_bf16 v[80:95], v[160:163], v[144:147], v[80:95]
    ds_read_b128 v[140:143], v130
    ds_read_b64_tr_b16 v[148:149], v136 offset:12288
    ds_read_b64_tr_b16 v[150:151], v136 offset:13824
    s_waitcnt lgkmcnt(5)
    v_mfma_f32_32x32x16_bf16 v[96:111], v[164:167], v[144:147], v[96:111]
    ds_read_b64_tr_b16 v[152:153], v136 offset:12416
    ds_read_b64_tr_b16 v[154:155], v136 offset:13952
    s_waitcnt lgkmcnt(5)
    v_mfma_f32_32x32x16_bf16 v[112:127], v[168:171], v[144:147], v[112:127]
    ds_read_b64_tr_b16 v[156:157], v136 offset:12544
    ds_read_b64_tr_b16 v[158:159], v136 offset:14080
    s_waitcnt lgkmcnt(4)
    v_mfma_f32_32x32x16_bf16 v[80:95], v[148:151], v[140:143], v[80:95]
    ds_read_b128 v[144:147], v131
    ds_read_b64_tr_b16 v[160:161], v136 offset:18432
    ds_read_b64_tr_b16 v[162:163], v136 offset:19968
    s_waitcnt lgkmcnt(5)
    v_mfma_f32_32x32x16_bf16 v[96:111], v[152:155], v[140:143], v[96:111]
    ds_read_b64_tr_b16 v[164:165], v136 offset:18560
    ds_read_b64_tr_b16 v[166:167], v136 offset:20096
    s_waitcnt lgkmcnt(5)
    v_mfma_f32_32x32x16_bf16 v[112:127], v[156:159], v[140:143], v[112:127]
    ds_read_b64_tr_b16 v[168:169], v136 offset:18688
    ds_read_b64_tr_b16 v[170:171], v136 offset:20224
    s_waitcnt lgkmcnt(4)
    v_mfma_f32_32x32x16_bf16 v[80:95], v[160:163], v[144:147], v[80:95]
    s_waitcnt lgkmcnt(0)
    s_barrier
    v_add_u32 v136, 0xffff4000, v136
    s_lshl_b32 s46, s50, 13
    v_add_u32 v128, s46, v132
    v_add_u32 v129, s46, v133
    v_add_u32 v130, s46, v134
    v_add_u32 v131, s46, v135
    s_add_u32 s50, s50, 1
    s_and_b32 s50, s50, 7
    ds_read_b128 v[140:143], v128
    ds_read_b64_tr_b16 v[148:149], v136 offset:0
    ds_read_b64_tr_b16 v[150:151], v136 offset:1536
    v_mfma_f32_32x32x16_bf16 v[96:111], v[164:167], v[144:147], v[96:111]
    ds_read_b64_tr_b16 v[152:153], v136 offset:128
    ds_read_b64_tr_b16 v[154:155], v136 offset:1664
    v_mfma_f32_32x32x16_bf16 v[112:127], v[168:171], v[144:147], v[112:127]
    ds_read_b64_tr_b16 v[156:157], v136 offset:256
    ds_read_b64_tr_b16 v[158:159], v136 offset:1792
    s_lshl_b32 s46, s57, 2
    v_mov_b32 v180, s46
    buffer_load_dword v181, v180, s[52:55], 0 offen offset:64 sc1
    s_waitcnt lgkmcnt(4)
    v_mfma_f32_32x32x16_bf16 v[80:95], v[148:151], v[140:143], v[80:95]
    ds_read_b128 v[144:147], v129
    ds_read_b64_tr_b16 v[160:161], v136 offset:6144
    ds_read_b64_tr_b16 v[162:163], v136 offset:7680
    s_waitcnt lgkmcnt(5)
    v_mfma_f32_32x32x16_bf16 v[96:111], v[152:155], v[140:143], v[96:111]
    ds_read_b64_tr_b16 v[164:165], v136 offset:6272
    ds_read_b64_tr_b16 v[166:167], v136 offset:7808
    s_waitcnt lgkmcnt(5)
    v_mfma_f32_32x32x16_bf16 v[112:127], v[156:159], v[140:143], v[112:127]
    ds_read_b64_tr_b16 v[168:169], v136 offset:6400
    ds_read_b64_tr_b16 v[170:171], v136 offset:7936
    s_waitcnt lgkmcnt(4)
    v_mfma_f32_32x32x16_bf16 v[80:95], v[160:163], v[144:147], v[80:95]
    ds_read_b128 v[140:143], v130
    ds_read_b64_tr_b16 v[148:149], v136 offset:12288
    ds_read_b64_tr_b16 v[150:151], v136 offset:13824
    s_waitcnt lgkmcnt(5)
    v_mfma_f32_32x32x16_bf16 v[96:111], v[164:167], v[144:147], v[96:111]
    ds_read_b64_tr_b16 v[152:153], v136 offset:12416
    ds_read_b64_tr_b16 v[154:155], v136 offset:13952
    s_waitcnt lgkmcnt(5)
    v_mfma_f32_32x32x16_bf16 v[112:127], v[168:171], v[144:147], v[112:127]
    ds_read_b64_tr_b16 v[156:157], v136 offset:12544
    ds_read_b64_tr_b16 v[158:159], v136 offset:14080
    s_waitcnt lgkmcnt(4)
    v_mfma_f32_32x32x16_bf16 v[80:95], v[148:151], v[140:143], v[80:95]
    ds_read_b128 v[144:147], v131
    ds_read_b64_tr_b16 v[160:161], v136 offset:18432
    ds_read_b64_tr_b16 v[162:163], v136 offset:19968
    s_waitcnt lgkmcnt(5)
    v_mfma_f32_32x32x16_bf16 v[96:111], v[152:155], v[140:143], v[96:111]
    ds_read_b64_tr_b16 v[164:165], v136 offset:18560
    ds_read_b64_tr_b16 v[166:167], v136 offset:20096
    s_waitcnt lgkmcnt(5)
    v_mfma_f32_32x32x16_bf16 v[112:127], v[156:159], v[140:143], v[112:127]
    ds_read_b64_tr_b16 v[168:169], v136 offset:18688
    ds_read_b64_tr_b16 v[170:171], v136 offset:20224
    s_waitcnt lgkmcnt(4)
    v_mfma_f32_32x32x16_bf16 v[80:95], v[160:163], v[144:147], v[80:95]
    s_waitcnt lgkmcnt(0)
    s_barrier
    v_add_u32 v136, 0x6000, v136
    s_lshl_b32 s46, s50, 13
    v_add_u32 v128, s46, v132
    v_add_u32 v129, s46, v133
    v_add_u32 v130, s46, v134
    v_add_u32 v131, s46, v135
    s_add_u32 s50, s50, 1
    s_and_b32 s50, s50, 7
    ds_read_b128 v[140:143], v128
    ds_read_b64_tr_b16 v[148:149], v136 offset:0
    ds_read_b64_tr_b16 v[150:151], v136 offset:1536
    v_mfma_f32_32x32x16_bf16 v[96:111], v[164:167], v[144:147], v[96:111]
    ds_read_b64_tr_b16 v[152:153], v136 offset:128
    ds_read_b64_tr_b16 v[154:155], v136 offset:1664
    v_mfma_f32_32x32x16_bf16 v[112:127], v[168:171], v[144:147], v[112:127]
    ds_read_b64_tr_b16 v[156:157], v136 offset:256
    ds_read_b64_tr_b16 v[158:159], v136 offset:1792
    s_waitcnt lgkmcnt(4)
    v_mfma_f32_32x32x16_bf16 v[80:95], v[148:151], v[140:143], v[80:95]
    ds_read_b128 v[144:147], v129
    ds_read_b64_tr_b16 v[160:161], v136 offset:6144
    ds_read_b64_tr_b16 v[162:163], v136 offset:7680
    s_waitcnt lgkmcnt(5)
    v_mfma_f32_32x32x16_bf16 v[96:111], v[152:155], v[140:143], v[96:111]
    ds_read_b64_tr_b16 v[164:165], v136 offset:6272
    ds_read_b64_tr_b16 v[166:167], v136 offset:7808
    s_waitcnt lgkmcnt(5)
    v_mfma_f32_32x32x16_bf16 v[112:127], v[156:159], v[140:143], v[112:127]
    ds_read_b64_tr_b16 v[168:169], v136 offset:6400
    ds_read_b64_tr_b16 v[170:171], v136 offset:7936
    s_waitcnt lgkmcnt(4)
    v_mfma_f32_32x32x16_bf16 v[80:95], v[160:163], v[144:147], v[80:95]
    ds_read_b128 v[140:143], v130
    ds_read_b64_tr_b16 v[148:149], v136 offset:12288
    ds_read_b64_tr_b16 v[150:151], v136 offset:13824
    s_waitcnt lgkmcnt(5)
    v_mfma_f32_32x32x16_bf16 v[96:111], v[164:167], v[144:147], v[96:111]
    ds_read_b64_tr_b16 v[152:153], v136 offset:12416
    ds_read_b64_tr_b16 v[154:155], v136 offset:13952
    s_waitcnt lgkmcnt(5)
    v_mfma_f32_32x32x16_bf16 v[112:127], v[168:171], v[144:147], v[112:127]
    ds_read_b64_tr_b16 v[156:157], v136 offset:12544
    ds_read_b64_tr_b16 v[158:159], v136 offset:14080
    s_waitcnt lgkmcnt(4)
    v_mfma_f32_32x32x16_bf16 v[80:95], v[148:151], v[140:143], v[80:95]
    ds_read_b128 v[144:147], v131
    ds_read_b64_tr_b16 v[160:161], v136 offset:18432
    ds_read_b64_tr_b16 v[162:163], v136 offset:19968
    s_waitcnt lgkmcnt(5)
    v_mfma_f32_32x32x16_bf16 v[96:111], v[152:155], v[140:143], v[96:111]
    ds_read_b64_tr_b16 v[164:165], v136 offset:18560
    ds_read_b64_tr_b16 v[166:167], v136 offset:20096
    s_waitcnt lgkmcnt(5)
    v_mfma_f32_32x32x16_bf16 v[112:127], v[156:159], v[140:143], v[112:127]
    ds_read_b64_tr_b16 v[168:169], v136 offset:18688
    ds_read_b64_tr_b16 v[170:171], v136 offset:20224
    s_waitcnt lgkmcnt(4)
    v_mfma_f32_32x32x16_bf16 v[80:95], v[160:163], v[144:147], v[80:95]
    s_waitcnt lgkmcnt(2)
    v_mfma_f32_32x32x16_bf16 v[96:111], v[164:167], v[144:147], v[96:111]
    s_waitcnt lgkmcnt(0)
    v_mfma_f32_32x32x16_bf16 v[112:127], v[168:171], v[144:147], v[112:127]
    s_barrier
    s_lshl_b32 s46, s25, 11
    v_lshlrev_b32 v172, 4, v0
    v_add_u32 v172, s46, v172
    s_nop 7
    v_cvt_pk_bf16_f32 v24, v80, v81
    v_cvt_pk_bf16_f32 v25, v82, v83
    v_cvt_pk_bf16_f32 v26, v84, v85
    v_cvt_pk_bf16_f32 v27, v86, v87
    v_cvt_pk_bf16_f32 v28, v88, v89
    v_cvt_pk_bf16_f32 v29, v90, v91
    v_cvt_pk_bf16_f32 v30, v92, v93
    v_cvt_pk_bf16_f32 v31, v94, v95
    ds_write_b128 v172, v[24:27] offset:8192
    ds_write_b128 v172, v[28:31] offset:9216
    s_waitcnt lgkmcnt(0)
    s_barrier
    v_cvt_pk_bf16_f32 v24, v96, v97
    v_cvt_pk_bf16_f32 v25, v98, v99
    v_cvt_pk_bf16_f32 v26, v100, v101
    v_cvt_pk_bf16_f32 v27, v102, v103
    v_cvt_pk_bf16_f32 v28, v104, v105
    v_cvt_pk_bf16_f32 v29, v106, v107
    v_cvt_pk_bf16_f32 v30, v108, v109
    v_cvt_pk_bf16_f32 v31, v110, v111
    v_cvt_pk_bf16_f32 v112, v112, v113
    v_cvt_pk_bf16_f32 v113, v114, v115
    v_cvt_pk_bf16_f32 v114, v116, v117
    v_cvt_pk_bf16_f32 v115, v118, v119
    v_cvt_pk_bf16_f32 v116, v120, v121
    v_cvt_pk_bf16_f32 v117, v122, v123
    v_cvt_pk_bf16_f32 v118, v124, v125
    v_cvt_pk_bf16_f32 v119, v126, v127
    v_and_b32 v172, 31, v0
    s_lshl_b32 s46, s60, 5
    v_add_u32 v172, s46, v172
    v_mul_u32_u24 v172, 160, v172
    v_lshrrev_b32 v173, 5, v0
    s_lshl_b32 s46, s61, 6
    v_lshl_add_u32 v174, v173, 5, v172
    v_add_u32 v174, s46, v174
    ds_write_b128 v174, v[112:115] offset:32768
    ds_write_b128 v174, v[116:119] offset:32784
    v_lshl_add_u32 v174, v173, 4, v172
    v_mov_b32 v120, 0x3f803f80
    v_mov_b32 v121, 0x3f803f80
    v_mov_b32 v122, 0x3f803f80
    v_mov_b32 v123, 0x3f803f80
    ds_write_b128 v174, v[120:123] offset:32896
    s_mov_b32 s59, 0
P1_SOFTMAX:
    s_nop 1
    v_mfma_f32_32x32x16_bf16 v[32:47], v[16:19], v[24:27], 0
    v_mfma_f32_32x32x16_bf16 v[32:47], v[20:23], v[28:31], v[32:47]
    s_nop 15
    v_max3_f32 v4, v32, v33, v34
    v_min3_f32 v5, v32, v33, v34
    v_max3_f32 v4, v4, v35, v36
    v_min3_f32 v5, v5, v35, v36
    v_max3_f32 v4, v4, v37, v38
    v_min3_f32 v5, v5, v37, v38
    v_max3_f32 v4, v4, v39, v40
    v_min3_f32 v5, v5, v39, v40
    v_max3_f32 v4, v4, v41, v42
    v_min3_f32 v5, v5, v41, v42
    v_max3_f32 v4, v4, v43, v44
    v_min3_f32 v5, v5, v43, v44
    v_max3_f32 v4, v4, v45, v46
    v_min3_f32 v5, v5, v45, v46
    v_max_f32 v4, v4, v47
    v_min_f32 v5, v5, v47
    v_mul_f32 v4, v12, v4
    v_mul_f32 v5, v12, v5
    v_fma_f32 v48, -v32, v12, v5
    v_fma_f32 v32, v32, v12, -v4
    v_fma_f32 v49, -v33, v12, v5
    v_fma_f32 v33, v33, v12, -v4
    v_fma_f32 v50, -v34, v12, v5
    v_fma_f32 v34, v34, v12, -v4
    v_fma_f32 v51, -v35, v12, v5
    v_fma_f32 v35, v35, v12, -v4
    v_fma_f32 v52, -v36, v12, v5
    v_fma_f32 v36, v36, v12, -v4
    v_fma_f32 v53, -v37, v12, v5
    v_fma_f32 v37, v37, v12, -v4
    v_fma_f32 v54, -v38, v12, v5
    v_fma_f32 v38, v38, v12, -v4
    v_fma_f32 v55, -v39, v12, v5
    v_fma_f32 v39, v39, v12, -v4
    v_fma_f32 v56, -v40, v12, v5
    v_fma_f32 v40, v40, v12, -v4
    v_fma_f32 v57, -v41, v12, v5
    v_fma_f32 v41, v41, v12, -v4
    v_fma_f32 v58, -v42, v12, v5
    v_fma_f32 v42, v42, v12, -v4
    v_fma_f32 v59, -v43, v12, v5
    v_fma_f32 v43, v43, v12, -v4
    v_fma_f32 v60, -v44, v12, v5
    v_fma_f32 v44, v44, v12, -v4
    v_fma_f32 v61, -v45, v12, v5
    v_fma_f32 v45, v45, v12, -v4
    v_fma_f32 v62, -v46, v12, v5
    v_fma_f32 v46, v46, v12, -v4
    v_fma_f32 v63, -v47, v12, v5
    v_fma_f32 v47, v47, v12, -v4
    v_exp_f32 v32, v32
    v_exp_f32 v48, v48
    v_exp_f32 v33, v33
    v_exp_f32 v49, v49
    v_exp_f32 v34, v34
    v_exp_f32 v50, v50
    v_exp_f32 v35, v35
    v_exp_f32 v51, v51
    v_exp_f32 v36, v36
    v_exp_f32 v52, v52
    v_exp_f32 v37, v37
    v_exp_f32 v53, v53
    v_exp_f32 v38, v38
    v_exp_f32 v54, v54
    v_exp_f32 v39, v39
    v_exp_f32 v55, v55
    v_exp_f32 v40, v40
    v_exp_f32 v56, v56
    v_exp_f32 v41, v41
    v_exp_f32 v57, v57
    v_exp_f32 v42, v42
    v_exp_f32 v58, v58
    v_exp_f32 v43, v43
    v_exp_f32 v59, v59
    v_exp_f32 v44, v44
    v_exp_f32 v60, v60
    v_exp_f32 v45, v45
    v_exp_f32 v61, v61
    v_exp_f32 v46, v46
    v_exp_f32 v62, v62
    v_exp_f32 v47, v47
    v_exp_f32 v63, v63
    v_pk_add_f32 v[6:7], v[32:33], v[34:35]
    v_pk_add_f32 v[8:9], v[48:49], v[50:51]
    v_pk_add_f32 v[6:7], v[6:7], v[36:37]
    v_pk_add_f32 v[8:9], v[8:9], v[52:53]
    v_pk_add_f32 v[6:7], v[6:7], v[38:39]
    v_pk_add_f32 v[8:9], v[8:9], v[54:55]
    v_pk_add_f32 v[6:7], v[6:7], v[40:41]
    v_pk_add_f32 v[8:9], v[8:9], v[56:57]
    v_pk_add_f32 v[6:7], v[6:7], v[42:43]
    v_pk_add_f32 v[8:9], v[8:9], v[58:59]
    v_pk_add_f32 v[6:7], v[6:7], v[44:45]
    v_pk_add_f32 v[8:9], v[8:9], v[60:61]
    v_pk_add_f32 v[6:7], v[6:7], v[46:47]
    v_pk_add_f32 v[8:9], v[8:9], v[62:63]
    v_add_f32 v6, v6, v7
    v_add_f32 v8, v8, v9
    v_rcp_f32 v6, v6
    v_rcp_f32 v8, v8
    s_nop 0
    v_pk_mul_f32 v[32:33], v[32:33], v[6:7] op_sel_hi:[1,0]
    v_pk_mul_f32 v[48:49], v[48:49], v[8:9] op_sel_hi:[1,0]
    v_pk_mul_f32 v[34:35], v[34:35], v[6:7] op_sel_hi:[1,0]
    v_pk_mul_f32 v[50:51], v[50:51], v[8:9] op_sel_hi:[1,0]
    v_pk_mul_f32 v[36:37], v[36:37], v[6:7] op_sel_hi:[1,0]
    v_pk_mul_f32 v[52:53], v[52:53], v[8:9] op_sel_hi:[1,0]
    v_pk_mul_f32 v[38:39], v[38:39], v[6:7] op_sel_hi:[1,0]
    v_pk_mul_f32 v[54:55], v[54:55], v[8:9] op_sel_hi:[1,0]
    v_pk_mul_f32 v[40:41], v[40:41], v[6:7] op_sel_hi:[1,0]
    v_pk_mul_f32 v[56:57], v[56:57], v[8:9] op_sel_hi:[1,0]
    v_pk_mul_f32 v[42:43], v[42:43], v[6:7] op_sel_hi:[1,0]
    v_pk_mul_f32 v[58:59], v[58:59], v[8:9] op_sel_hi:[1,0]
    v_pk_mul_f32 v[44:45], v[44:45], v[6:7] op_sel_hi:[1,0]
    v_pk_mul_f32 v[60:61], v[60:61], v[8:9] op_sel_hi:[1,0]
    v_pk_mul_f32 v[46:47], v[46:47], v[6:7] op_sel_hi:[1,0]
    v_pk_mul_f32 v[62:63], v[62:63], v[8:9] op_sel_hi:[1,0]
    v_cvt_pk_bf16_f32 v64, v32, v33
    v_cvt_pk_bf16_f32 v72, v48, v49
    v_cvt_pk_bf16_f32 v65, v34, v35
    v_cvt_pk_bf16_f32 v73, v50, v51
    v_cvt_pk_bf16_f32 v66, v36, v37
    v_cvt_pk_bf16_f32 v74, v52, v53
    v_cvt_pk_bf16_f32 v67, v38, v39
    v_cvt_pk_bf16_f32 v75, v54, v55
    v_cvt_pk_bf16_f32 v68, v40, v41
    v_cvt_pk_bf16_f32 v76, v56, v57
    v_cvt_pk_bf16_f32 v69, v42, v43
    v_cvt_pk_bf16_f32 v77, v58, v59
    v_cvt_pk_bf16_f32 v70, v44, v45
    v_cvt_pk_bf16_f32 v78, v60, v61
    v_cvt_pk_bf16_f32 v71, v46, v47
    v_cvt_pk_bf16_f32 v79, v62, v63
    s_cmp_eq_u32 s59, 0
    s_cbranch_scc1 P1_CONS2
    s_lshl_b32 s44, s56, 1
    s_and_b32 s45, s25, 1
    s_add_u32 s44, s44, s45
    s_lshl_b32 s44, s44, 5
    s_lshl_b32 s45, s57, 2
    s_add_u32 s44, s44, s45
    s_lshr_b32 s45, s25, 1
    s_lshl_b32 s45, s45, 1
    s_add_u32 s44, s44, s45
    s_lshl_b32 s44, s44, 11
    s_add_u32 s44, s44, 1048576
    v_and_b32 v4, 31, v0
    v_lshrrev_b32 v5, 5, v0
    v_lshlrev_b32 v4, 4, v4
    v_lshl_add_u32 v4, v5, 11, v4
    buffer_store_dwordx4 v[64:67], v4, s[28:31], s44 offen offset:0 sc1
    buffer_store_dwordx4 v[68:71], v4, s[28:31], s44 offen offset:512 sc1
    buffer_store_dwordx4 v[72:75], v4, s[28:31], s44 offen offset:1024 sc1
    buffer_store_dwordx4 v[76:79], v4, s[28:31], s44 offen offset:1536 sc1
    s_waitcnt vmcnt(7)
    v_lshlrev_b32 v112, 16, v88
    v_and_b32 v113, 0xffff0000, v88
    v_mov_b32 v104, v112
    v_mov_b32 v105, v113
    v_lshlrev_b32 v112, 16, v89
    v_and_b32 v113, 0xffff0000, v89
    v_mov_b32 v106, v112
    v_mov_b32 v107, v113
    v_lshlrev_b32 v112, 16, v90
    v_and_b32 v113, 0xffff0000, v90
    v_mov_b32 v108, v112
    v_mov_b32 v109, v113
    v_lshlrev_b32 v112, 16, v91
    v_and_b32 v113, 0xffff0000, v91
    v_mov_b32 v110, v112
    v_mov_b32 v111, v113
    v_lshlrev_b32 v112, 16, v92
    v_and_b32 v113, 0xffff0000, v92
    v_pk_add_f32 v[104:105], v[104:105], v[112:113]
    v_lshlrev_b32 v112, 16, v93
    v_and_b32 v113, 0xffff0000, v93
    v_pk_add_f32 v[106:107], v[106:107], v[112:113]
    v_lshlrev_b32 v112, 16, v94
    v_and_b32 v113, 0xffff0000, v94
    v_pk_add_f32 v[108:109], v[108:109], v[112:113]
    v_lshlrev_b32 v112, 16, v95
    v_and_b32 v113, 0xffff0000, v95
    v_pk_add_f32 v[110:111], v[110:111], v[112:113]
    v_lshlrev_b32 v112, 16, v96
    v_and_b32 v113, 0xffff0000, v96
    v_pk_add_f32 v[104:105], v[104:105], v[112:113]
    v_lshlrev_b32 v112, 16, v97
    v_and_b32 v113, 0xffff0000, v97
    v_pk_add_f32 v[106:107], v[106:107], v[112:113]
    v_lshlrev_b32 v112, 16, v98
    v_and_b32 v113, 0xffff0000, v98
    v_pk_add_f32 v[108:109], v[108:109], v[112:113]
    v_lshlrev_b32 v112, 16, v99
    v_and_b32 v113, 0xffff0000, v99
    v_pk_add_f32 v[110:111], v[110:111], v[112:113]
    v_lshlrev_b32 v112, 16, v100
    v_and_b32 v113, 0xffff0000, v100
    v_pk_add_f32 v[104:105], v[104:105], v[112:113]
    v_lshlrev_b32 v112, 16, v101
    v_and_b32 v113, 0xffff0000, v101
    v_pk_add_f32 v[106:107], v[106:107], v[112:113]
    v_lshlrev_b32 v112, 16, v102
    v_and_b32 v113, 0xffff0000, v102
    v_pk_add_f32 v[108:109], v[108:109], v[112:113]
    v_lshlrev_b32 v112, 16, v103
    v_and_b32 v113, 0xffff0000, v103
    v_pk_add_f32 v[110:111], v[110:111], v[112:113]
    s_nop 1
    v_add_f32_dpp v104, v104, v104 row_ror:8 row_mask:0xf bank_mask:0xf
    v_add_f32_dpp v105, v105, v105 row_ror:8 row_mask:0xf bank_mask:0xf
    v_add_f32_dpp v106, v106, v106 row_ror:8 row_mask:0xf bank_mask:0xf
    v_add_f32_dpp v107, v107, v107 row_ror:8 row_mask:0xf bank_mask:0xf
    v_add_f32_dpp v108, v108, v108 row_ror:8 row_mask:0xf bank_mask:0xf
    v_add_f32_dpp v109, v109, v109 row_ror:8 row_mask:0xf bank_mask:0xf
    v_add_f32_dpp v110, v110, v110 row_ror:8 row_mask:0xf bank_mask:0xf
    v_add_f32_dpp v111, v111, v111 row_ror:8 row_mask:0xf bank_mask:0xf
    v_mov_b32 v112, v104
    v_mov_b32 v113, v105
    v_mov_b32 v114, v106
    v_mov_b32 v115, v107
    v_mov_b32 v116, v108
    v_mov_b32 v117, v109
    v_mov_b32 v118, v110
    v_mov_b32 v119, v111
    s_nop 1
    v_permlane16_swap_b32 v104, v112
    v_permlane16_swap_b32 v105, v113
    v_permlane16_swap_b32 v106, v114
    v_permlane16_swap_b32 v107, v115
    v_permlane16_swap_b32 v108, v116
    v_permlane16_swap_b32 v109, v117
    v_permlane16_swap_b32 v110, v118
    v_permlane16_swap_b32 v111, v119
    s_nop 1
    v_add_f32 v104, v104, v112
    v_add_f32 v105, v105, v113
    v_add_f32 v106, v106, v114
    v_add_f32 v107, v107, v115
    v_add_f32 v108, v108, v116
    v_add_f32 v109, v109, v117
    v_add_f32 v110, v110, v118
    v_add_f32 v111, v111, v119
    v_mov_b32 v112, v104
    v_mov_b32 v113, v105
    v_mov_b32 v114, v106
    v_mov_b32 v115, v107
    v_mov_b32 v116, v108
    v_mov_b32 v117, v109
    v_mov_b32 v118, v110
    v_mov_b32 v119, v111
    s_nop 1
    v_permlane32_swap_b32 v104, v112
    v_permlane32_swap_b32 v105, v113
    v_permlane32_swap_b32 v106, v114
    v_permlane32_swap_b32 v107, v115
    v_permlane32_swap_b32 v108, v116
    v_permlane32_swap_b32 v109, v117
    v_permlane32_swap_b32 v110, v118
    v_permlane32_swap_b32 v111, v119
    s_nop 1
    v_add_f32 v104, v104, v112
    v_add_f32 v105, v105, v113
    v_add_f32 v106, v106, v114
    v_add_f32 v107, v107, v115
    v_add_f32 v108, v108, v116
    v_add_f32 v109, v109, v117
    v_add_f32 v110, v110, v118
    v_add_f32 v111, v111, v119
    v_lshlrev_b32 v112, 5, v0
    v_cmp_gt_u32 vcc, 8, v0
    s_and_saveexec_b64 s[48:49], vcc
    buffer_store_dwordx4 v[104:107], v112, s[28:31], s51 offen offset:0 sc1
    buffer_store_dwordx4 v[108:111], v112, s[28:31], s51 offen offset:16 sc1
    s_mov_b64 exec, s[48:49]
    s_branch P1_DONE
P1_CONS2:
    v_and_b32 v4, 3, v0
    v_lshlrev_b32 v4, 2, v4
    v_and_b32 v5, 2, v0
    v_or_b32 v4, v4, v5
    v_bfe_u32 v5, v0, 2, 1
    v_or_b32 v4, v4, v5
    v_lshrrev_b32 v5, 5, v0
    s_lshl_b32 s46, s61, 1
    v_add_u32 v5, s46, v5
    v_lshlrev_b32 v5, 2, v5
    v_xor_b32 v4, v4, v5
    v_and_b32 v5, 31, v0
    s_lshl_b32 s46, s60, 5
    v_add_u32 v5, s46, v5
    v_lshlrev_b32 v5, 8, v5
    v_lshl_add_u32 v4, v4, 4, v5
    ds_write_b128 v4, v[64:67] offset:16384
    v_xor_b32 v5, 16, v4
    ds_write_b128 v5, v[68:71] offset:16384
    v_xor_b32 v5, 32, v4
    ds_write_b128 v5, v[72:75] offset:16384
    v_xor_b32 v5, 48, v4
    ds_write_b128 v5, v[76:79] offset:16384
    s_waitcnt lgkmcnt(0)
    v_mov_b32 v10, 2064
    v_mov_b32 v11, 1
    v_cmp_eq_u32 vcc, 0, v0
    s_and_saveexec_b64 s[48:49], vcc
    ds_add_u32 v10, v11
    s_mov_b64 exec, s[48:49]
P1_RDV:
    ds_read_b32 v11, v10
    s_waitcnt lgkmcnt(0)
    v_readfirstlane_b32 s46, v11
    s_nop 3
    s_cmp_lt_u32 s46, 4
    s_cbranch_scc1 P1_RDV
    v_lshrrev_b32 v4, 5, v0
    v_lshlrev_b32 v4, 3, v4
    v_bfe_u32 v5, v0, 2, 2
    v_add_u32 v4, v4, v5
    v_and_b32 v6, 3, v0
    v_mul_u32_u24 v7, 160, v4
    v_lshl_add_u32 v7, v6, 3, v7
    s_lshl_b32 s46, s24, 5
    v_mov_b32 v8, s46
    v_bfe_u32 v9, v0, 4, 1
    v_cmp_eq_u32 vcc, 1, v9
    v_mov_b32 v10, 128
    s_nop 0
    v_cndmask_b32 v8, v8, v10, vcc
    v_add_u32 v7, v7, v8
    v_lshrrev_b32 v8, 1, v6
    v_lshl_add_u32 v8, v9, 1, v8
    s_lshl_b32 s46, s24, 2
    v_add_u32 v8, s46, v8
    v_lshlrev_b32 v9, 2, v5
    v_and_b32 v10, 2, v5
    v_or_b32 v9, v9, v10
    v_xor_b32 v8, v8, v9
    v_lshlrev_b32 v8, 4, v8
    v_lshl_add_u32 v8, v4, 8, v8
    v_and_b32 v9, 1, v6
    v_lshl_add_u32 v8, v9, 3, v8
    v_xor_b32 v9, 16, v8
    ds_read_b64_tr_b16 v[48:49], v7 offset:32768
    ds_read_b64_tr_b16 v[50:51], v7 offset:33408
    ds_read_b64_tr_b16 v[56:57], v8 offset:16384
    ds_read_b64_tr_b16 v[58:59], v9 offset:17408
    ds_read_b64_tr_b16 v[52:53], v7 offset:35328
    ds_read_b64_tr_b16 v[54:55], v7 offset:35968
    ds_read_b64_tr_b16 v[60:61], v8 offset:20480
    ds_read_b64_tr_b16 v[62:63], v9 offset:21504
    s_waitcnt lgkmcnt(4)
    v_mfma_f32_32x32x16_bf16 v[32:47], v[48:51], v[56:59], 0
    ds_read_b64_tr_b16 v[48:49], v7 offset:37888
    ds_read_b64_tr_b16 v[50:51], v7 offset:38528
    ds_read_b64_tr_b16 v[56:57], v8 offset:24576
    ds_read_b64_tr_b16 v[58:59], v9 offset:25600
    s_waitcnt lgkmcnt(4)
    v_mfma_f32_32x32x16_bf16 v[32:47], v[52:55], v[60:63], v[32:47]
    ds_read_b64_tr_b16 v[52:53], v7 offset:40448
    ds_read_b64_tr_b16 v[54:55], v7 offset:41088
    ds_read_b64_tr_b16 v[60:61], v8 offset:28672
    ds_read_b64_tr_b16 v[62:63], v9 offset:29696
    s_waitcnt lgkmcnt(4)
    v_mfma_f32_32x32x16_bf16 v[32:47], v[48:51], v[56:59], v[32:47]
    s_waitcnt lgkmcnt(0)
    v_mfma_f32_32x32x16_bf16 v[32:47], v[52:55], v[60:63], v[32:47]
    s_waitcnt vmcnt(0)
    s_mov_b32 s47, 0
P1_POLL:
    v_readfirstlane_b32 s46, v181
    s_add_u32 s47, s47, 1
    s_nop 2
    s_cmp_lg_u32 s46, 0
    s_cbranch_scc1 P1_GO
    s_cmp_ge_u32 s47, 40000
    s_cbranch_scc1 P1_GO
    buffer_load_dword v181, v180, s[52:55], 0 offen offset:64 sc1
    s_waitcnt vmcnt(0)
    s_branch P1_POLL
P1_GO:
    s_lshl_b32 s46, s57, 2
    s_add_u32 s46, s46, s24
    s_mul_i32 s46, s46, 2176
    s_add_u32 s46, s46, 0
    v_and_b32 v4, 31, v0
    v_lshlrev_b32 v4, 2, v4
    v_lshrrev_b32 v5, 5, v0
    v_lshl_add_u32 v6, v5, 9, v4
    s_nop 7
    buffer_atomic_add_f32 v32, v6, s[28:31], s46 offen offset:0
    buffer_atomic_add_f32 v33, v6, s[28:31], s46 offen offset:128
    buffer_atomic_add_f32 v34, v6, s[28:31], s46 offen offset:256
    buffer_atomic_add_f32 v35, v6, s[28:31], s46 offen offset:384
    buffer_atomic_add_f32 v36, v6, s[28:31], s46 offen offset:1024
    buffer_atomic_add_f32 v37, v6, s[28:31], s46 offen offset:1152
    buffer_atomic_add_f32 v38, v6, s[28:31], s46 offen offset:1280
    buffer_atomic_add_f32 v39, v6, s[28:31], s46 offen offset:1408
    v_cmp_gt_u32 vcc, 32, v0
    s_and_saveexec_b64 s[48:49], vcc
    buffer_atomic_add_f32 v40, v4, s[28:31], s46 offen offset:2048
    s_mov_b64 exec, s[48:49]
P1_DONE:
    s_and_b32 s44, s2, 7
    s_lshr_b32 s45, s2, 3
    s_lshl_b32 s56, s44, 2
    s_and_b32 s46, s45, 3
    s_add_u32 s56, s56, s46
    s_lshr_b32 s57, s45, 2
    s_cmp_ge_u32 s24, 4
    s_cbranch_scc0 P2_CONS
    v_lshrrev_b32 v6, 3, v0
    v_lshlrev_b32 v6, 10, v6
    v_bfe_u32 v7, v0, 4, 1
    v_lshlrev_b32 v7, 2, v7
    v_and_b32 v8, 7, v0
    v_xor_b32 v7, v7, v8
    v_lshl_add_u32 v2, v7, 4, v6
    v_lshlrev_b32 v3, 4, v0
    s_mov_b32 s36, s10
    s_and_b32 s37, s11, 0xffff
    s_mov_b32 s38, 524288
    s_mov_b32 s39, 0x20000
    s_waitcnt vmcnt(0)
    s_barrier
    s_barrier
    s_lshl_b32 s59, s25, 17
    s_lshl_b32 s46, s57, 7
    s_add_u32 s59, s59, s46
    s_lshl_b32 s60, s25, 14
    s_add_u32 s61, s57, 0
    s_and_b32 s61, s61, 7
    s_lshl_b32 s62, s61, 14
    s_add_u32 s62, s62, s59
    s_add_u32 m0, s60, 73728
    s_nop 0
    buffer_load_dwordx4 v2, s[36:39], s62 offen lds
    s_add_u32 m0, s60, 74752
    s_add_u32 s62, s62, 8192
    buffer_load_dwordx4 v2, s[36:39], s62 offen lds
    s_add_u32 s61, s57, 1
    s_and_b32 s61, s61, 7
    s_lshl_b32 s62, s61, 14
    s_add_u32 s62, s62, s59
    s_add_u32 m0, s60, 75776
    s_nop 0
    buffer_load_dwordx4 v2, s[36:39], s62 offen lds
    s_add_u32 m0, s60, 76800
    s_add_u32 s62, s62, 8192
    buffer_load_dwordx4 v2, s[36:39], s62 offen lds
    s_add_u32 s61, s57, 2
    s_and_b32 s61, s61, 7
    s_lshl_b32 s62, s61, 14
    s_add_u32 s62, s62, s59
    s_add_u32 m0, s60, 77824
    s_nop 0
    buffer_load_dwordx4 v2, s[36:39], s62 offen lds
    s_add_u32 m0, s60, 78848
    s_add_u32 s62, s62, 8192
    buffer_load_dwordx4 v2, s[36:39], s62 offen lds
    s_add_u32 s61, s57, 3
    s_and_b32 s61, s61, 7
    s_lshl_b32 s62, s61, 14
    s_add_u32 s62, s62, s59
    s_add_u32 m0, s60, 79872
    s_nop 0
    buffer_load_dwordx4 v2, s[36:39], s62 offen lds
    s_add_u32 m0, s60, 80896
    s_add_u32 s62, s62, 8192
    buffer_load_dwordx4 v2, s[36:39], s62 offen lds
    s_add_u32 s61, s57, 4
    s_and_b32 s61, s61, 7
    s_lshl_b32 s62, s61, 14
    s_add_u32 s62, s62, s59
    s_add_u32 m0, s60, 81920
    s_nop 0
    buffer_load_dwordx4 v2, s[36:39], s62 offen lds
    s_add_u32 m0, s60, 82944
    s_add_u32 s62, s62, 8192
    buffer_load_dwordx4 v2, s[36:39], s62 offen lds
    s_add_u32 s61, s57, 5
    s_and_b32 s61, s61, 7
    s_lshl_b32 s62, s61, 14
    s_add_u32 s62, s62, s59
    s_add_u32 m0, s60, 83968
    s_nop 0
    buffer_load_dwordx4 v2, s[36:39], s62 offen lds
    s_add_u32 m0, s60, 84992
    s_add_u32 s62, s62, 8192
    buffer_load_dwordx4 v2, s[36:39], s62 offen lds
    s_add_u32 s61, s57, 6
    s_and_b32 s61, s61, 7
    s_lshl_b32 s62, s61, 14
    s_add_u32 s62, s62, s59
    s_add_u32 m0, s60, 86016
    s_nop 0
    buffer_load_dwordx4 v2, s[36:39], s62 offen lds
    s_add_u32 m0, s60, 87040
    s_add_u32 s62, s62, 8192
    buffer_load_dwordx4 v2, s[36:39], s62 offen lds
    s_add_u32 s61, s57, 7
    s_and_b32 s61, s61, 7
    s_lshl_b32 s62, s61, 14
    s_add_u32 s62, s62, s59
    s_add_u32 m0, s60, 88064
    s_nop 0
    buffer_load_dwordx4 v2, s[36:39], s62 offen lds
    s_add_u32 m0, s60, 89088
    s_add_u32 s62, s62, 8192
    buffer_load_dwordx4 v2, s[36:39], s62 offen lds
    s_barrier
    s_mul_i32 s44, s25, 17408
    s_add_u32 s44, s44, 0
    s_lshr_b32 s47, s2, 3
    s_cmp_ge_u32 s47, 17
    s_cselect_b32 s46, 17, 0
    s_sub_u32 s47, s47, s46
    s_mov_b32 s61, s47
    s_lshl_b32 s45, s61, 10
    s_add_u32 s45, s45, s44
    buffer_load_dwordx4 v[12:15], v3, s[28:31], s45 offen sc1
    s_add_u32 s61, s61, 1
    s_cmp_eq_u32 s61, 17
    s_cselect_b32 s61, 0, s61
    s_lshl_b32 s45, s61, 10
    s_add_u32 s45, s45, s44
    buffer_load_dwordx4 v[16:19], v3, s[28:31], s45 offen sc1
    s_add_u32 s61, s61, 1
    s_cmp_eq_u32 s61, 17
    s_cselect_b32 s61, 0, s61
    s_lshl_b32 s45, s61, 10
    s_add_u32 s45, s45, s44
    buffer_load_dwordx4 v[20:23], v3, s[28:31], s45 offen sc1
    s_add_u32 s61, s61, 1
    s_cmp_eq_u32 s61, 17
    s_cselect_b32 s61, 0, s61
    s_lshl_b32 s45, s61, 10
    s_add_u32 s45, s45, s44
    buffer_load_dwordx4 v[24:27], v3, s[28:31], s45 offen sc1
    s_add_u32 s61, s61, 1
    s_cmp_eq_u32 s61, 17
    s_cselect_b32 s61, 0, s61
    s_lshl_b32 s45, s61, 10
    s_add_u32 s45, s45, s44
    buffer_load_dwordx4 v[28:31], v3, s[28:31], s45 offen sc1
    s_add_u32 s61, s61, 1
    s_cmp_eq_u32 s61, 17
    s_cselect_b32 s61, 0, s61
    s_lshl_b32 s45, s61, 10
    s_add_u32 s45, s45, s44
    buffer_load_dwordx4 v[32:35], v3, s[28:31], s45 offen sc1
    s_add_u32 s61, s61, 1
    s_cmp_eq_u32 s61, 17
    s_cselect_b32 s61, 0, s61
    s_lshl_b32 s45, s61, 10
    s_add_u32 s45, s45, s44
    buffer_load_dwordx4 v[36:39], v3, s[28:31], s45 offen sc1
    s_add_u32 s61, s61, 1
    s_cmp_eq_u32 s61, 17
    s_cselect_b32 s61, 0, s61
    s_lshl_b32 s45, s61, 10
    s_add_u32 s45, s45, s44
    buffer_load_dwordx4 v[40:43], v3, s[28:31], s45 offen sc1
    s_add_u32 s61, s61, 1
    s_cmp_eq_u32 s61, 17
    s_cselect_b32 s61, 0, s61
    s_lshl_b32 s45, s61, 10
    s_add_u32 s45, s45, s44
    buffer_load_dwordx4 v[44:47], v3, s[28:31], s45 offen sc1
    s_add_u32 s61, s61, 1
    s_cmp_eq_u32 s61, 17
    s_cselect_b32 s61, 0, s61
    s_lshl_b32 s45, s61, 10
    s_add_u32 s45, s45, s44
    buffer_load_dwordx4 v[48:51], v3, s[28:31], s45 offen sc1
    s_add_u32 s61, s61, 1
    s_cmp_eq_u32 s61, 17
    s_cselect_b32 s61, 0, s61
    s_lshl_b32 s45, s61, 10
    s_add_u32 s45, s45, s44
    buffer_load_dwordx4 v[52:55], v3, s[28:31], s45 offen sc1
    s_add_u32 s61, s61, 1
    s_cmp_eq_u32 s61, 17
    s_cselect_b32 s61, 0, s61
    s_lshl_b32 s45, s61, 10
    s_add_u32 s45, s45, s44
    buffer_load_dwordx4 v[56:59], v3, s[28:31], s45 offen sc1
    s_add_u32 s61, s61, 1
    s_cmp_eq_u32 s61, 17
    s_cselect_b32 s61, 0, s61
    s_lshl_b32 s45, s61, 10
    s_add_u32 s45, s45, s44
    buffer_load_dwordx4 v[60:63], v3, s[28:31], s45 offen sc1
    s_add_u32 s61, s61, 1
    s_cmp_eq_u32 s61, 17
    s_cselect_b32 s61, 0, s61
    s_lshl_b32 s45, s61, 10
    s_add_u32 s45, s45, s44
    buffer_load_dwordx4 v[64:67], v3, s[28:31], s45 offen sc1
    s_add_u32 s61, s61, 1
    s_cmp_eq_u32 s61, 17
    s_cselect_b32 s61, 0, s61
    s_lshl_b32 s45, s61, 10
    s_add_u32 s45, s45, s44
    buffer_load_dwordx4 v[68:71], v3, s[28:31], s45 offen sc1
    s_add_u32 s61, s61, 1
    s_cmp_eq_u32 s61, 17
    s_cselect_b32 s61, 0, s61
    s_lshl_b32 s45, s61, 10
    s_add_u32 s45, s45, s44
    buffer_load_dwordx4 v[72:75], v3, s[28:31], s45 offen sc1
    s_add_u32 s61, s61, 1
    s_cmp_eq_u32 s61, 17
    s_cselect_b32 s61, 0, s61
    s_lshl_b32 s45, s61, 10
    s_add_u32 s45, s45, s44
    buffer_load_dwordx4 v[76:79], v3, s[28:31], s45 offen sc1
    s_add_u32 s61, s61, 1
    s_cmp_eq_u32 s61, 17
    s_cselect_b32 s61, 0, s61
    s_mul_i32 s44, s25, 8704
    s_add_u32 s44, s44, 8192
    v_lshlrev_b32 v4, 3, v0
    v_add_u32 v4, s44, v4
    s_mov_b32 s61, s47
    s_waitcnt vmcnt(13)
    s_lshl_b32 s45, s61, 9
    v_add_u32 v6, s45, v4
    v_cvt_pk_bf16_f32 v12, v12, v13
    v_cvt_pk_bf16_f32 v13, v14, v15
    ds_write_b64 v6, v[12:13]
    s_add_u32 s61, s61, 1
    s_cmp_eq_u32 s61, 17
    s_cselect_b32 s61, 0, s61
    s_lshl_b32 s45, s61, 9
    v_add_u32 v6, s45, v4
    v_cvt_pk_bf16_f32 v16, v16, v17
    v_cvt_pk_bf16_f32 v17, v18, v19
    ds_write_b64 v6, v[16:17]
    s_add_u32 s61, s61, 1
    s_cmp_eq_u32 s61, 17
    s_cselect_b32 s61, 0, s61
    s_lshl_b32 s45, s61, 9
    v_add_u32 v6, s45, v4
    v_cvt_pk_bf16_f32 v20, v20, v21
    v_cvt_pk_bf16_f32 v21, v22, v23
    ds_write_b64 v6, v[20:21]
    s_add_u32 s61, s61, 1
    s_cmp_eq_u32 s61, 17
    s_cselect_b32 s61, 0, s61
    s_lshl_b32 s45, s61, 9
    v_add_u32 v6, s45, v4
    v_cvt_pk_bf16_f32 v24, v24, v25
    v_cvt_pk_bf16_f32 v25, v26, v27
    ds_write_b64 v6, v[24:25]
    s_add_u32 s61, s61, 1
    s_cmp_eq_u32 s61, 17
    s_cselect_b32 s61, 0, s61
    s_waitcnt vmcnt(9)
    s_lshl_b32 s45, s61, 9
    v_add_u32 v6, s45, v4
    v_cvt_pk_bf16_f32 v28, v28, v29
    v_cvt_pk_bf16_f32 v29, v30, v31
    ds_write_b64 v6, v[28:29]
    s_add_u32 s61, s61, 1
    s_cmp_eq_u32 s61, 17
    s_cselect_b32 s61, 0, s61
    s_lshl_b32 s45, s61, 9
    v_add_u32 v6, s45, v4
    v_cvt_pk_bf16_f32 v32, v32, v33
    v_cvt_pk_bf16_f32 v33, v34, v35
    ds_write_b64 v6, v[32:33]
    s_add_u32 s61, s61, 1
    s_cmp_eq_u32 s61, 17
    s_cselect_b32 s61, 0, s61
    s_lshl_b32 s45, s61, 9
    v_add_u32 v6, s45, v4
    v_cvt_pk_bf16_f32 v36, v36, v37
    v_cvt_pk_bf16_f32 v37, v38, v39
    ds_write_b64 v6, v[36:37]
    s_add_u32 s61, s61, 1
    s_cmp_eq_u32 s61, 17
    s_cselect_b32 s61, 0, s61
    s_lshl_b32 s45, s61, 9
    v_add_u32 v6, s45, v4
    v_cvt_pk_bf16_f32 v40, v40, v41
    v_cvt_pk_bf16_f32 v41, v42, v43
    ds_write_b64 v6, v[40:41]
    s_add_u32 s61, s61, 1
    s_cmp_eq_u32 s61, 17
    s_cselect_b32 s61, 0, s61
    s_waitcnt vmcnt(5)
    s_lshl_b32 s45, s61, 9
    v_add_u32 v6, s45, v4
    v_cvt_pk_bf16_f32 v44, v44, v45
    v_cvt_pk_bf16_f32 v45, v46, v47
    ds_write_b64 v6, v[44:45]
    s_add_u32 s61, s61, 1
    s_cmp_eq_u32 s61, 17
    s_cselect_b32 s61, 0, s61
    s_lshl_b32 s45, s61, 9
    v_add_u32 v6, s45, v4
    v_cvt_pk_bf16_f32 v48, v48, v49
    v_cvt_pk_bf16_f32 v49, v50, v51
    ds_write_b64 v6, v[48:49]
    s_add_u32 s61, s61, 1
    s_cmp_eq_u32 s61, 17
    s_cselect_b32 s61, 0, s61
    s_lshl_b32 s45, s61, 9
    v_add_u32 v6, s45, v4
    v_cvt_pk_bf16_f32 v52, v52, v53
    v_cvt_pk_bf16_f32 v53, v54, v55
    ds_write_b64 v6, v[52:53]
    s_add_u32 s61, s61, 1
    s_cmp_eq_u32 s61, 17
    s_cselect_b32 s61, 0, s61
    s_lshl_b32 s45, s61, 9
    v_add_u32 v6, s45, v4
    v_cvt_pk_bf16_f32 v56, v56, v57
    v_cvt_pk_bf16_f32 v57, v58, v59
    ds_write_b64 v6, v[56:57]
    s_add_u32 s61, s61, 1
    s_cmp_eq_u32 s61, 17
    s_cselect_b32 s61, 0, s61
    s_waitcnt vmcnt(1)
    s_lshl_b32 s45, s61, 9
    v_add_u32 v6, s45, v4
    v_cvt_pk_bf16_f32 v60, v60, v61
    v_cvt_pk_bf16_f32 v61, v62, v63
    ds_write_b64 v6, v[60:61]
    s_add_u32 s61, s61, 1
    s_cmp_eq_u32 s61, 17
    s_cselect_b32 s61, 0, s61
    s_lshl_b32 s45, s61, 9
    v_add_u32 v6, s45, v4
    v_cvt_pk_bf16_f32 v64, v64, v65
    v_cvt_pk_bf16_f32 v65, v66, v67
    ds_write_b64 v6, v[64:65]
    s_add_u32 s61, s61, 1
    s_cmp_eq_u32 s61, 17
    s_cselect_b32 s61, 0, s61
    s_lshl_b32 s45, s61, 9
    v_add_u32 v6, s45, v4
    v_cvt_pk_bf16_f32 v68, v68, v69
    v_cvt_pk_bf16_f32 v69, v70, v71
    ds_write_b64 v6, v[68:69]
    s_add_u32 s61, s61, 1
    s_cmp_eq_u32 s61, 17
    s_cselect_b32 s61, 0, s61
    s_lshl_b32 s45, s61, 9
    v_add_u32 v6, s45, v4
    v_cvt_pk_bf16_f32 v72, v72, v73
    v_cvt_pk_bf16_f32 v73, v74, v75
    ds_write_b64 v6, v[72:73]
    s_add_u32 s61, s61, 1
    s_cmp_eq_u32 s61, 17
    s_cselect_b32 s61, 0, s61
    s_waitcnt vmcnt(0)
    s_lshl_b32 s45, s61, 9
    v_add_u32 v6, s45, v4
    v_cvt_pk_bf16_f32 v76, v76, v77
    v_cvt_pk_bf16_f32 v77, v78, v79
    ds_write_b64 v6, v[76:77]
    s_add_u32 s61, s61, 1
    s_cmp_eq_u32 s61, 17
    s_cselect_b32 s61, 0, s61
    s_waitcnt vmcnt(0) lgkmcnt(0)
    s_barrier
    s_barrier
    s_mov_b32 s36, s14
    s_and_b32 s37, s15, 0xffff
    s_mov_b32 s38, 1835008
    s_mov_b32 s39, 0x20000
    s_lshr_b32 s47, s2, 3
    s_mul_i32 s46, s47, 57344
    s_bfe_u32 s47, s2, 0x10002
    s_mul_i32 s47, s47, 1792
    s_add_u32 s46, s46, s47
    s_lshl_b32 s47, s25, 6
    v_add_u32 v6, s47, v0
    v_mul_u32_u24 v7, 2341, v6
    v_lshrrev_b32 v7, 15, v7
    v_mul_u32_u24 v8, 14, v7
    v_sub_u32 v8, v6, v8
    v_mul_u32_u24 v7, 3584, v7
    v_lshl_add_u32 v8, v8, 7, v7
    v_cmp_gt_u32 vcc, 224, v6
    s_and_saveexec_b64 s[48:49], vcc
    buffer_load_dword v255, v8, s[36:39], s46 offen
    s_mov_b64 exec, s[48:49]
    s_barrier
    s_branch P2_DONE
P2_CONS:
    v_lshlrev_b32 v2, 4, v0
    s_mov_b32 s32, s4
    s_and_b32 s33, s5, 0xffff
    s_mov_b32 s34, 2097152
    s_mov_b32 s35, 0x20000
    s_waitcnt vmcnt(0)
    s_barrier
    s_cmp_eq_u32 s24, 0
    s_cbranch_scc0 SIG1C
    s_lshl_b32 s44, s2, 7
    s_add_u32 s44, s44, 8126464
    v_mov_b32 v6, 0
    v_mov_b32 v7, s26
    v_cmp_eq_u32 vcc, 0, v0
    s_and_saveexec_b64 s[48:49], vcc
    buffer_store_dword v7, v6, s[28:31], s44 offen sc1
    s_mov_b64 exec, s[48:49]
SIG1C:
    s_barrier
    v_and_b32 v6, 31, v0
    v_lshlrev_b32 v6, 10, v6
    v_lshrrev_b32 v7, 5, v0
    v_lshl_add_u32 v6, v7, 4, v6
    s_and_b32 s44, s24, 1
    s_lshl_b32 s50, s56, 1
    s_add_u32 s50, s50, s44
    s_lshl_b32 s45, s50, 15
    s_lshr_b32 s46, s24, 1
    s_lshl_b32 s51, s57, 1
    s_add_u32 s51, s51, s46
    s_lshl_b32 s46, s51, 6
    s_add_u32 s45, s45, s46
    buffer_load_dwordx4 v[16:19], v6, s[32:35], s45 offen offset:0
    buffer_load_dwordx4 v[20:23], v6, s[32:35], s45 offen offset:32
    s_mul_i32 s44, s24, 8704
    s_add_u32 s44, s44, 8192
    v_and_b32 v8, 31, v0
    v_min_u32 v8, 16, v8
    v_lshlrev_b32 v8, 6, v8
    v_lshrrev_b32 v9, 5, v0
    v_lshl_add_u32 v8, v9, 4, v8
    v_add_u32 v3, s44, v8
    v_lshrrev_b32 v8, 5, v0
    v_lshlrev_b32 v8, 2, v8
    v_bfe_u32 v9, v0, 2, 2
    v_add_u32 v8, v8, v9
    v_lshlrev_b32 v8, 7, v8
    v_bfe_u32 v9, v0, 3, 1
    v_lshl_add_u32 v8, v9, 6, v8
    v_bfe_u32 v9, v0, 4, 1
    v_lshl_add_u32 v8, v9, 5, v8
    v_and_b32 v9, 1, v0
    v_lshl_add_u32 v8, v9, 4, v8
    v_bfe_u32 v9, v0, 1, 1
    v_lshl_add_u32 v8, v9, 3, v8
    s_lshl_b32 s44, s24, 14
    s_add_u32 s44, s44, 73728
    v_add_u32 v4, s44, v8
    v_xor_b32 v5, 64, v4
    v_mov_b32 v24, 0
    v_mov_b32 v25, 0
    v_mov_b32 v26, 0
    v_mov_b32 v27, 0
    v_mov_b32 v28, 0
    v_mov_b32 v29, 0
    v_mov_b32 v30, 0
    v_mov_b32 v31, 0
    v_mov_b32 v32, 0
    v_mov_b32 v33, 0
    v_mov_b32 v34, 0
    v_mov_b32 v35, 0
    v_mov_b32 v36, 0
    v_mov_b32 v37, 0
    v_mov_b32 v38, 0
    v_mov_b32 v39, 0
    v_mov_b32 v40, 0
    v_mov_b32 v41, 0
    v_mov_b32 v42, 0
    v_mov_b32 v43, 0
    v_mov_b32 v44, 0
    v_mov_b32 v45, 0
    v_mov_b32 v46, 0
    v_mov_b32 v47, 0
    v_mov_b32 v48, 0
    v_mov_b32 v49, 0
    v_mov_b32 v50, 0
    v_mov_b32 v51, 0
    v_mov_b32 v52, 0
    v_mov_b32 v53, 0
    v_mov_b32 v54, 0
    v_mov_b32 v55, 0
    v_mov_b32 v56, 0
    v_mov_b32 v57, 0
    v_mov_b32 v58, 0
    v_mov_b32 v59, 0
    v_mov_b32 v60, 0
    v_mov_b32 v61, 0
    v_mov_b32 v62, 0
    v_mov_b32 v63, 0
    v_mov_b32 v64, 0
    v_mov_b32 v65, 0
    v_mov_b32 v66, 0
    v_mov_b32 v67, 0
    v_mov_b32 v68, 0
    v_mov_b32 v69, 0
    v_mov_b32 v70, 0
    v_mov_b32 v71, 0
    v_mov_b32 v72, 0
    v_mov_b32 v73, 0
    v_mov_b32 v74, 0
    v_mov_b32 v75, 0
    v_mov_b32 v76, 0
    v_mov_b32 v77, 0
    v_mov_b32 v78, 0
    v_mov_b32 v79, 0
    v_mov_b32 v80, 0
    v_mov_b32 v81, 0
    v_mov_b32 v82, 0
    v_mov_b32 v83, 0
    v_mov_b32 v84, 0
    v_mov_b32 v85, 0
    v_mov_b32 v86, 0
    v_mov_b32 v87, 0
    s_lshl_b32 s58, s56, 6
    s_lshl_b32 s44, s24, 3
    s_add_u32 s58, s58, s44
    s_lshl_b32 s58, s58, 11
    s_add_u32 s58, s58, 1048576
    s_lshl_b32 s44, s24, 13
    s_add_u32 s44, s44, 8126464
    v_lshlrev_b32 v88, 7, v0
    s_mov_b32 s45, 0
    buffer_load_dword v89, v88, s[28:31], s44 offen sc1
POL1C:
    buffer_load_dword v90, v88, s[28:31], s44 offen sc1
    s_waitcnt vmcnt(1)
    v_cmp_ne_u32 vcc, s26, v89
    s_nop 1
    s_cmp_eq_u64 vcc, 0
    s_cbranch_scc1 WAD1C
    buffer_load_dword v89, v88, s[28:31], s44 offen sc1
    s_waitcnt vmcnt(1)
    v_cmp_ne_u32 vcc, s26, v90
    s_nop 1
    s_cmp_eq_u64 vcc, 0
    s_cbranch_scc1 WAD1C
    s_add_u32 s45, s45, 1
    s_cmp_lt_u32 s45, 20000
    s_cbranch_scc1 POL1C
WAD1C:
    s_barrier
    s_add_u32 s61, s57, 0
    s_and_b32 s61, s61, 7
    s_lshl_b32 s62, s61, 11
    s_add_u32 s62, s62, s58
    s_add_u32 s63, s62, 65536
    buffer_load_dwordx4 v[184:187], v2, s[28:31], s62 offen offset:0 sc1
    buffer_load_dwordx4 v[188:191], v2, s[28:31], s62 offen offset:1024 sc1
    buffer_load_dwordx4 v[192:195], v2, s[28:31], s63 offen offset:0 sc1
    buffer_load_dwordx4 v[196:199], v2, s[28:31], s63 offen offset:1024 sc1
    s_add_u32 s61, s57, 1
    s_and_b32 s61, s61, 7
    s_lshl_b32 s62, s61, 11
    s_add_u32 s62, s62, s58
    s_add_u32 s63, s62, 65536
    buffer_load_dwordx4 v[200:203], v2, s[28:31], s62 offen offset:0 sc1
    buffer_load_dwordx4 v[204:207], v2, s[28:31], s62 offen offset:1024 sc1
    buffer_load_dwordx4 v[208:211], v2, s[28:31], s63 offen offset:0 sc1
    buffer_load_dwordx4 v[212:215], v2, s[28:31], s63 offen offset:1024 sc1
    s_add_u32 s61, s57, 2
    s_and_b32 s61, s61, 7
    s_lshl_b32 s62, s61, 11
    s_add_u32 s62, s62, s58
    s_add_u32 s63, s62, 65536
    buffer_load_dwordx4 v[216:219], v2, s[28:31], s62 offen offset:0 sc1
    buffer_load_dwordx4 v[220:223], v2, s[28:31], s62 offen offset:1024 sc1
    buffer_load_dwordx4 v[224:227], v2, s[28:31], s63 offen offset:0 sc1
    buffer_load_dwordx4 v[228:231], v2, s[28:31], s63 offen offset:1024 sc1
    s_barrier
    s_add_u32 s61, s57, 0
    s_and_b32 s61, s61, 7
    s_mul_i32 s61, s61, 1088
    v_add_u32 v12, s61, v3
    ds_read_b128 v[152:155], v12 offset:0
    ds_read_b128 v[156:159], v12 offset:32
    s_waitcnt vmcnt(8)
    s_waitcnt lgkmcnt(0)
    v_mfma_f32_32x32x16_bf16 v[88:103], v[152:155], v[184:187], 0
    v_mfma_f32_32x32x16_bf16 v[104:119], v[152:155], v[192:195], 0
    v_mfma_f32_32x32x16_bf16 v[88:103], v[156:159], v[188:191], v[88:103]
    v_mfma_f32_32x32x16_bf16 v[104:119], v[156:159], v[196:199], v[104:119]
    s_add_u32 s61, s57, 3
    s_and_b32 s61, s61, 7
    s_lshl_b32 s62, s61, 11
    s_add_u32 s62, s62, s58
    s_add_u32 s63, s62, 65536
    buffer_load_dwordx4 v[232:235], v2, s[28:31], s62 offen offset:0 sc1
    buffer_load_dwordx4 v[236:239], v2, s[28:31], s62 offen offset:1024 sc1
    buffer_load_dwordx4 v[240:243], v2, s[28:31], s63 offen offset:0 sc1
    buffer_load_dwordx4 v[244:247], v2, s[28:31], s63 offen offset:1024 sc1
    s_add_u32 s61, s57, 1
    s_and_b32 s61, s61, 7
    s_mul_i32 s61, s61, 1088
    v_add_u32 v12, s61, v3
    ds_read_b128 v[152:155], v12 offset:0
    ds_read_b128 v[156:159], v12 offset:32
    ds_read_b64_tr_b16 v[160:161], v4 offset:0
    ds_read_b64_tr_b16 v[162:163], v4 offset:1024
    ds_read_b64_tr_b16 v[164:165], v5 offset:0
    ds_read_b64_tr_b16 v[166:167], v5 offset:1024
    s_waitcnt vmcnt(8)
    s_waitcnt lgkmcnt(4)
    v_mfma_f32_32x32x16_bf16 v[120:135], v[152:155], v[200:203], 0
    v_mfma_f32_32x32x16_bf16 v[136:151], v[152:155], v[208:211], 0
    v_mfma_f32_32x32x16_bf16 v[120:135], v[156:159], v[204:207], v[120:135]
    v_mfma_f32_32x32x16_bf16 v[136:151], v[156:159], v[212:215], v[136:151]
    s_add_u32 s61, s57, 4
    s_and_b32 s61, s61, 7
    s_lshl_b32 s62, s61, 11
    s_add_u32 s62, s62, s58
    s_add_u32 s63, s62, 65536
    buffer_load_dwordx4 v[184:187], v2, s[28:31], s62 offen offset:0 sc1
    buffer_load_dwordx4 v[188:191], v2, s[28:31], s62 offen offset:1024 sc1
    buffer_load_dwordx4 v[192:195], v2, s[28:31], s63 offen offset:0 sc1
    buffer_load_dwordx4 v[196:199], v2, s[28:31], s63 offen offset:1024 sc1
    s_add_u32 s61, s57, 2
    s_and_b32 s61, s61, 7
    s_mul_i32 s61, s61, 1088
    v_add_u32 v12, s61, v3
    ds_read_b128 v[152:155], v12 offset:0
    ds_read_b128 v[156:159], v12 offset:32
    ds_read_b64_tr_b16 v[168:169], v4 offset:2048
    ds_read_b64_tr_b16 v[170:171], v4 offset:3072
    ds_read_b64_tr_b16 v[172:173], v5 offset:2048
    ds_read_b64_tr_b16 v[174:175], v5 offset:3072
    v_add_f32 v96, 0x358637bd, v96
    v_rcp_f32 v96, v96
    v_add_f32 v112, 0x358637bd, v112
    v_rcp_f32 v112, v112
    s_nop 0
    v_pk_mul_f32 v[88:89], v[88:89], v[96:97] op_sel_hi:[1,0]
    v_pk_mul_f32 v[90:91], v[90:91], v[96:97] op_sel_hi:[1,0]
    v_pk_mul_f32 v[92:93], v[92:93], v[96:97] op_sel_hi:[1,0]
    v_pk_mul_f32 v[94:95], v[94:95], v[96:97] op_sel_hi:[1,0]
    v_pk_mul_f32 v[104:105], v[104:105], v[112:113] op_sel_hi:[1,0]
    v_pk_mul_f32 v[106:107], v[106:107], v[112:113] op_sel_hi:[1,0]
    v_pk_mul_f32 v[108:109], v[108:109], v[112:113] op_sel_hi:[1,0]
    v_pk_mul_f32 v[110:111], v[110:111], v[112:113] op_sel_hi:[1,0]
    v_cvt_pk_bf16_f32 v176, v88, v89
    v_cvt_pk_bf16_f32 v177, v90, v91
    v_cvt_pk_bf16_f32 v178, v92, v93
    v_cvt_pk_bf16_f32 v179, v94, v95
    v_cvt_pk_bf16_f32 v180, v104, v105
    v_cvt_pk_bf16_f32 v181, v106, v107
    v_cvt_pk_bf16_f32 v182, v108, v109
    v_cvt_pk_bf16_f32 v183, v110, v111
    s_waitcnt lgkmcnt(6)
    s_nop 1
    v_mfma_f32_32x32x16_bf16 v[24:39], v[160:163], v[176:179], v[24:39]
    v_mfma_f32_32x32x16_bf16 v[40:55], v[160:163], v[180:183], v[40:55]
    v_mfma_f32_32x32x16_bf16 v[56:71], v[164:167], v[176:179], v[56:71]
    v_mfma_f32_32x32x16_bf16 v[72:87], v[164:167], v[180:183], v[72:87]
    s_waitcnt vmcnt(8)
    s_waitcnt lgkmcnt(4)
    v_mfma_f32_32x32x16_bf16 v[88:103], v[152:155], v[216:219], 0
    v_mfma_f32_32x32x16_bf16 v[104:119], v[152:155], v[224:227], 0
    v_mfma_f32_32x32x16_bf16 v[88:103], v[156:159], v[220:223], v[88:103]
    v_mfma_f32_32x32x16_bf16 v[104:119], v[156:159], v[228:231], v[104:119]
    s_add_u32 s61, s57, 5
    s_and_b32 s61, s61, 7
    s_lshl_b32 s62, s61, 11
    s_add_u32 s62, s62, s58
    s_add_u32 s63, s62, 65536
    buffer_load_dwordx4 v[200:203], v2, s[28:31], s62 offen offset:0 sc1
    buffer_load_dwordx4 v[204:207], v2, s[28:31], s62 offen offset:1024 sc1
    buffer_load_dwordx4 v[208:211], v2, s[28:31], s63 offen offset:0 sc1
    buffer_load_dwordx4 v[212:215], v2, s[28:31], s63 offen offset:1024 sc1
    s_add_u32 s61, s57, 3
    s_and_b32 s61, s61, 7
    s_mul_i32 s61, s61, 1088
    v_add_u32 v12, s61, v3
    ds_read_b128 v[152:155], v12 offset:0
    ds_read_b128 v[156:159], v12 offset:32
    ds_read_b64_tr_b16 v[160:161], v4 offset:4096
    ds_read_b64_tr_b16 v[162:163], v4 offset:5120
    ds_read_b64_tr_b16 v[164:165], v5 offset:4096
    ds_read_b64_tr_b16 v[166:167], v5 offset:5120
    v_add_f32 v128, 0x358637bd, v128
    v_rcp_f32 v128, v128
    v_add_f32 v144, 0x358637bd, v144
    v_rcp_f32 v144, v144
    s_nop 0
    v_pk_mul_f32 v[120:121], v[120:121], v[128:129] op_sel_hi:[1,0]
    v_pk_mul_f32 v[122:123], v[122:123], v[128:129] op_sel_hi:[1,0]
    v_pk_mul_f32 v[124:125], v[124:125], v[128:129] op_sel_hi:[1,0]
    v_pk_mul_f32 v[126:127], v[126:127], v[128:129] op_sel_hi:[1,0]
    v_pk_mul_f32 v[136:137], v[136:137], v[144:145] op_sel_hi:[1,0]
    v_pk_mul_f32 v[138:139], v[138:139], v[144:145] op_sel_hi:[1,0]
    v_pk_mul_f32 v[140:141], v[140:141], v[144:145] op_sel_hi:[1,0]
    v_pk_mul_f32 v[142:143], v[142:143], v[144:145] op_sel_hi:[1,0]
    v_cvt_pk_bf16_f32 v176, v120, v121
    v_cvt_pk_bf16_f32 v177, v122, v123
    v_cvt_pk_bf16_f32 v178, v124, v125
    v_cvt_pk_bf16_f32 v179, v126, v127
    v_cvt_pk_bf16_f32 v180, v136, v137
    v_cvt_pk_bf16_f32 v181, v138, v139
    v_cvt_pk_bf16_f32 v182, v140, v141
    v_cvt_pk_bf16_f32 v183, v142, v143
    s_waitcnt lgkmcnt(6)
    s_nop 1
    v_mfma_f32_32x32x16_bf16 v[24:39], v[168:171], v[176:179], v[24:39]
    v_mfma_f32_32x32x16_bf16 v[40:55], v[168:171], v[180:183], v[40:55]
    v_mfma_f32_32x32x16_bf16 v[56:71], v[172:175], v[176:179], v[56:71]
    v_mfma_f32_32x32x16_bf16 v[72:87], v[172:175], v[180:183], v[72:87]
    s_waitcnt vmcnt(8)
    s_waitcnt lgkmcnt(4)
    v_mfma_f32_32x32x16_bf16 v[120:135], v[152:155], v[232:235], 0
    v_mfma_f32_32x32x16_bf16 v[136:151], v[152:155], v[240:243], 0
    v_mfma_f32_32x32x16_bf16 v[120:135], v[156:159], v[236:239], v[120:135]
    v_mfma_f32_32x32x16_bf16 v[136:151], v[156:159], v[244:247], v[136:151]
    s_add_u32 s61, s57, 6
    s_and_b32 s61, s61, 7
    s_lshl_b32 s62, s61, 11
    s_add_u32 s62, s62, s58
    s_add_u32 s63, s62, 65536
    buffer_load_dwordx4 v[216:219], v2, s[28:31], s62 offen offset:0 sc1
    buffer_load_dwordx4 v[220:223], v2, s[28:31], s62 offen offset:1024 sc1
    buffer_load_dwordx4 v[224:227], v2, s[28:31], s63 offen offset:0 sc1
    buffer_load_dwordx4 v[228:231], v2, s[28:31], s63 offen offset:1024 sc1
    s_add_u32 s61, s57, 4
    s_and_b32 s61, s61, 7
    s_mul_i32 s61, s61, 1088
    v_add_u32 v12, s61, v3
    ds_read_b128 v[152:155], v12 offset:0
    ds_read_b128 v[156:159], v12 offset:32
    ds_read_b64_tr_b16 v[168:169], v4 offset:6144
    ds_read_b64_tr_b16 v[170:171], v4 offset:7168
    ds_read_b64_tr_b16 v[172:173], v5 offset:6144
    ds_read_b64_tr_b16 v[174:175], v5 offset:7168
    v_add_f32 v96, 0x358637bd, v96
    v_rcp_f32 v96, v96
    v_add_f32 v112, 0x358637bd, v112
    v_rcp_f32 v112, v112
    s_nop 0
    v_pk_mul_f32 v[88:89], v[88:89], v[96:97] op_sel_hi:[1,0]
    v_pk_mul_f32 v[90:91], v[90:91], v[96:97] op_sel_hi:[1,0]
    v_pk_mul_f32 v[92:93], v[92:93], v[96:97] op_sel_hi:[1,0]
    v_pk_mul_f32 v[94:95], v[94:95], v[96:97] op_sel_hi:[1,0]
    v_pk_mul_f32 v[104:105], v[104:105], v[112:113] op_sel_hi:[1,0]
    v_pk_mul_f32 v[106:107], v[106:107], v[112:113] op_sel_hi:[1,0]
    v_pk_mul_f32 v[108:109], v[108:109], v[112:113] op_sel_hi:[1,0]
    v_pk_mul_f32 v[110:111], v[110:111], v[112:113] op_sel_hi:[1,0]
    v_cvt_pk_bf16_f32 v176, v88, v89
    v_cvt_pk_bf16_f32 v177, v90, v91
    v_cvt_pk_bf16_f32 v178, v92, v93
    v_cvt_pk_bf16_f32 v179, v94, v95
    v_cvt_pk_bf16_f32 v180, v104, v105
    v_cvt_pk_bf16_f32 v181, v106, v107
    v_cvt_pk_bf16_f32 v182, v108, v109
    v_cvt_pk_bf16_f32 v183, v110, v111
    s_waitcnt lgkmcnt(6)
    s_nop 1
    v_mfma_f32_32x32x16_bf16 v[24:39], v[160:163], v[176:179], v[24:39]
    v_mfma_f32_32x32x16_bf16 v[40:55], v[160:163], v[180:183], v[40:55]
    v_mfma_f32_32x32x16_bf16 v[56:71], v[164:167], v[176:179], v[56:71]
    v_mfma_f32_32x32x16_bf16 v[72:87], v[164:167], v[180:183], v[72:87]
    s_waitcnt vmcnt(8)
    s_waitcnt lgkmcnt(4)
    v_mfma_f32_32x32x16_bf16 v[88:103], v[152:155], v[184:187], 0
    v_mfma_f32_32x32x16_bf16 v[104:119], v[152:155], v[192:195], 0
    v_mfma_f32_32x32x16_bf16 v[88:103], v[156:159], v[188:191], v[88:103]
    v_mfma_f32_32x32x16_bf16 v[104:119], v[156:159], v[196:199], v[104:119]
    s_add_u32 s61, s57, 7
    s_and_b32 s61, s61, 7
    s_lshl_b32 s62, s61, 11
    s_add_u32 s62, s62, s58
    s_add_u32 s63, s62, 65536
    buffer_load_dwordx4 v[232:235], v2, s[28:31], s62 offen offset:0 sc1
    buffer_load_dwordx4 v[236:239], v2, s[28:31], s62 offen offset:1024 sc1
    buffer_load_dwordx4 v[240:243], v2, s[28:31], s63 offen offset:0 sc1
    buffer_load_dwordx4 v[244:247], v2, s[28:31], s63 offen offset:1024 sc1
    s_add_u32 s61, s57, 5
    s_and_b32 s61, s61, 7
    s_mul_i32 s61, s61, 1088
    v_add_u32 v12, s61, v3
    ds_read_b128 v[152:155], v12 offset:0
    ds_read_b128 v[156:159], v12 offset:32
    ds_read_b64_tr_b16 v[160:161], v4 offset:8192
    ds_read_b64_tr_b16 v[162:163], v4 offset:9216
    ds_read_b64_tr_b16 v[164:165], v5 offset:8192
    ds_read_b64_tr_b16 v[166:167], v5 offset:9216
    v_add_f32 v128, 0x358637bd, v128
    v_rcp_f32 v128, v128
    v_add_f32 v144, 0x358637bd, v144
    v_rcp_f32 v144, v144
    s_nop 0
    v_pk_mul_f32 v[120:121], v[120:121], v[128:129] op_sel_hi:[1,0]
    v_pk_mul_f32 v[122:123], v[122:123], v[128:129] op_sel_hi:[1,0]
    v_pk_mul_f32 v[124:125], v[124:125], v[128:129] op_sel_hi:[1,0]
    v_pk_mul_f32 v[126:127], v[126:127], v[128:129] op_sel_hi:[1,0]
    v_pk_mul_f32 v[136:137], v[136:137], v[144:145] op_sel_hi:[1,0]
    v_pk_mul_f32 v[138:139], v[138:139], v[144:145] op_sel_hi:[1,0]
    v_pk_mul_f32 v[140:141], v[140:141], v[144:145] op_sel_hi:[1,0]
    v_pk_mul_f32 v[142:143], v[142:143], v[144:145] op_sel_hi:[1,0]
    v_cvt_pk_bf16_f32 v176, v120, v121
    v_cvt_pk_bf16_f32 v177, v122, v123
    v_cvt_pk_bf16_f32 v178, v124, v125
    v_cvt_pk_bf16_f32 v179, v126, v127
    v_cvt_pk_bf16_f32 v180, v136, v137
    v_cvt_pk_bf16_f32 v181, v138, v139
    v_cvt_pk_bf16_f32 v182, v140, v141
    v_cvt_pk_bf16_f32 v183, v142, v143
    s_waitcnt lgkmcnt(6)
    s_nop 1
    v_mfma_f32_32x32x16_bf16 v[24:39], v[168:171], v[176:179], v[24:39]
    v_mfma_f32_32x32x16_bf16 v[40:55], v[168:171], v[180:183], v[40:55]
    v_mfma_f32_32x32x16_bf16 v[56:71], v[172:175], v[176:179], v[56:71]
    v_mfma_f32_32x32x16_bf16 v[72:87], v[172:175], v[180:183], v[72:87]
    s_waitcnt vmcnt(8)
    s_waitcnt lgkmcnt(4)
    v_mfma_f32_32x32x16_bf16 v[120:135], v[152:155], v[200:203], 0
    v_mfma_f32_32x32x16_bf16 v[136:151], v[152:155], v[208:211], 0
    v_mfma_f32_32x32x16_bf16 v[120:135], v[156:159], v[204:207], v[120:135]
    v_mfma_f32_32x32x16_bf16 v[136:151], v[156:159], v[212:215], v[136:151]
    s_add_u32 s61, s57, 6
    s_and_b32 s61, s61, 7
    s_mul_i32 s61, s61, 1088
    v_add_u32 v12, s61, v3
    ds_read_b128 v[152:155], v12 offset:0
    ds_read_b128 v[156:159], v12 offset:32
    ds_read_b64_tr_b16 v[168:169], v4 offset:10240
    ds_read_b64_tr_b16 v[170:171], v4 offset:11264
    ds_read_b64_tr_b16 v[172:173], v5 offset:10240
    ds_read_b64_tr_b16 v[174:175], v5 offset:11264
    v_add_f32 v96, 0x358637bd, v96
    v_rcp_f32 v96, v96
    v_add_f32 v112, 0x358637bd, v112
    v_rcp_f32 v112, v112
    s_nop 0
    v_pk_mul_f32 v[88:89], v[88:89], v[96:97] op_sel_hi:[1,0]
    v_pk_mul_f32 v[90:91], v[90:91], v[96:97] op_sel_hi:[1,0]
    v_pk_mul_f32 v[92:93], v[92:93], v[96:97] op_sel_hi:[1,0]
    v_pk_mul_f32 v[94:95], v[94:95], v[96:97] op_sel_hi:[1,0]
    v_pk_mul_f32 v[104:105], v[104:105], v[112:113] op_sel_hi:[1,0]
    v_pk_mul_f32 v[106:107], v[106:107], v[112:113] op_sel_hi:[1,0]
    v_pk_mul_f32 v[108:109], v[108:109], v[112:113] op_sel_hi:[1,0]
    v_pk_mul_f32 v[110:111], v[110:111], v[112:113] op_sel_hi:[1,0]
    v_cvt_pk_bf16_f32 v176, v88, v89
    v_cvt_pk_bf16_f32 v177, v90, v91
    v_cvt_pk_bf16_f32 v178, v92, v93
    v_cvt_pk_bf16_f32 v179, v94, v95
    v_cvt_pk_bf16_f32 v180, v104, v105
    v_cvt_pk_bf16_f32 v181, v106, v107
    v_cvt_pk_bf16_f32 v182, v108, v109
    v_cvt_pk_bf16_f32 v183, v110, v111
    s_waitcnt lgkmcnt(6)
    s_nop 1
    v_mfma_f32_32x32x16_bf16 v[24:39], v[160:163], v[176:179], v[24:39]
    v_mfma_f32_32x32x16_bf16 v[40:55], v[160:163], v[180:183], v[40:55]
    v_mfma_f32_32x32x16_bf16 v[56:71], v[164:167], v[176:179], v[56:71]
    v_mfma_f32_32x32x16_bf16 v[72:87], v[164:167], v[180:183], v[72:87]
    s_waitcnt vmcnt(4)
    s_waitcnt lgkmcnt(4)
    v_mfma_f32_32x32x16_bf16 v[88:103], v[152:155], v[216:219], 0
    v_mfma_f32_32x32x16_bf16 v[104:119], v[152:155], v[224:227], 0
    v_mfma_f32_32x32x16_bf16 v[88:103], v[156:159], v[220:223], v[88:103]
    v_mfma_f32_32x32x16_bf16 v[104:119], v[156:159], v[228:231], v[104:119]
    s_add_u32 s61, s57, 7
    s_and_b32 s61, s61, 7
    s_mul_i32 s61, s61, 1088
    v_add_u32 v12, s61, v3
    ds_read_b128 v[152:155], v12 offset:0
    ds_read_b128 v[156:159], v12 offset:32
    ds_read_b64_tr_b16 v[160:161], v4 offset:12288
    ds_read_b64_tr_b16 v[162:163], v4 offset:13312
    ds_read_b64_tr_b16 v[164:165], v5 offset:12288
    ds_read_b64_tr_b16 v[166:167], v5 offset:13312
    v_add_f32 v128, 0x358637bd, v128
    v_rcp_f32 v128, v128
    v_add_f32 v144, 0x358637bd, v144
    v_rcp_f32 v144, v144
    s_nop 0
    v_pk_mul_f32 v[120:121], v[120:121], v[128:129] op_sel_hi:[1,0]
    v_pk_mul_f32 v[122:123], v[122:123], v[128:129] op_sel_hi:[1,0]
    v_pk_mul_f32 v[124:125], v[124:125], v[128:129] op_sel_hi:[1,0]
    v_pk_mul_f32 v[126:127], v[126:127], v[128:129] op_sel_hi:[1,0]
    v_pk_mul_f32 v[136:137], v[136:137], v[144:145] op_sel_hi:[1,0]
    v_pk_mul_f32 v[138:139], v[138:139], v[144:145] op_sel_hi:[1,0]
    v_pk_mul_f32 v[140:141], v[140:141], v[144:145] op_sel_hi:[1,0]
    v_pk_mul_f32 v[142:143], v[142:143], v[144:145] op_sel_hi:[1,0]
    v_cvt_pk_bf16_f32 v176, v120, v121
    v_cvt_pk_bf16_f32 v177, v122, v123
    v_cvt_pk_bf16_f32 v178, v124, v125
    v_cvt_pk_bf16_f32 v179, v126, v127
    v_cvt_pk_bf16_f32 v180, v136, v137
    v_cvt_pk_bf16_f32 v181, v138, v139
    v_cvt_pk_bf16_f32 v182, v140, v141
    v_cvt_pk_bf16_f32 v183, v142, v143
    s_waitcnt lgkmcnt(6)
    s_nop 1
    v_mfma_f32_32x32x16_bf16 v[24:39], v[168:171], v[176:179], v[24:39]
    v_mfma_f32_32x32x16_bf16 v[40:55], v[168:171], v[180:183], v[40:55]
    v_mfma_f32_32x32x16_bf16 v[56:71], v[172:175], v[176:179], v[56:71]
    v_mfma_f32_32x32x16_bf16 v[72:87], v[172:175], v[180:183], v[72:87]
    s_waitcnt vmcnt(0)
    s_waitcnt lgkmcnt(4)
    v_mfma_f32_32x32x16_bf16 v[120:135], v[152:155], v[232:235], 0
    v_mfma_f32_32x32x16_bf16 v[136:151], v[152:155], v[240:243], 0
    v_mfma_f32_32x32x16_bf16 v[120:135], v[156:159], v[236:239], v[120:135]
    v_mfma_f32_32x32x16_bf16 v[136:151], v[156:159], v[244:247], v[136:151]
    ds_read_b64_tr_b16 v[168:169], v4 offset:14336
    ds_read_b64_tr_b16 v[170:171], v4 offset:15360
    ds_read_b64_tr_b16 v[172:173], v5 offset:14336
    ds_read_b64_tr_b16 v[174:175], v5 offset:15360
    v_add_f32 v96, 0x358637bd, v96
    v_rcp_f32 v96, v96
    v_add_f32 v112, 0x358637bd, v112
    v_rcp_f32 v112, v112
    s_nop 0
    v_pk_mul_f32 v[88:89], v[88:89], v[96:97] op_sel_hi:[1,0]
    v_pk_mul_f32 v[90:91], v[90:91], v[96:97] op_sel_hi:[1,0]
    v_pk_mul_f32 v[92:93], v[92:93], v[96:97] op_sel_hi:[1,0]
    v_pk_mul_f32 v[94:95], v[94:95], v[96:97] op_sel_hi:[1,0]
    v_pk_mul_f32 v[104:105], v[104:105], v[112:113] op_sel_hi:[1,0]
    v_pk_mul_f32 v[106:107], v[106:107], v[112:113] op_sel_hi:[1,0]
    v_pk_mul_f32 v[108:109], v[108:109], v[112:113] op_sel_hi:[1,0]
    v_pk_mul_f32 v[110:111], v[110:111], v[112:113] op_sel_hi:[1,0]
    v_cvt_pk_bf16_f32 v176, v88, v89
    v_cvt_pk_bf16_f32 v177, v90, v91
    v_cvt_pk_bf16_f32 v178, v92, v93
    v_cvt_pk_bf16_f32 v179, v94, v95
    v_cvt_pk_bf16_f32 v180, v104, v105
    v_cvt_pk_bf16_f32 v181, v106, v107
    v_cvt_pk_bf16_f32 v182, v108, v109
    v_cvt_pk_bf16_f32 v183, v110, v111
    s_waitcnt lgkmcnt(4)
    s_nop 1
    v_mfma_f32_32x32x16_bf16 v[24:39], v[160:163], v[176:179], v[24:39]
    v_mfma_f32_32x32x16_bf16 v[40:55], v[160:163], v[180:183], v[40:55]
    v_mfma_f32_32x32x16_bf16 v[56:71], v[164:167], v[176:179], v[56:71]
    v_mfma_f32_32x32x16_bf16 v[72:87], v[164:167], v[180:183], v[72:87]
    s_nop 7
    s_nop 3
    v_add_f32 v128, 0x358637bd, v128
    v_rcp_f32 v128, v128
    v_add_f32 v144, 0x358637bd, v144
    v_rcp_f32 v144, v144
    s_nop 0
    v_pk_mul_f32 v[120:121], v[120:121], v[128:129] op_sel_hi:[1,0]
    v_pk_mul_f32 v[122:123], v[122:123], v[128:129] op_sel_hi:[1,0]
    v_pk_mul_f32 v[124:125], v[124:125], v[128:129] op_sel_hi:[1,0]
    v_pk_mul_f32 v[126:127], v[126:127], v[128:129] op_sel_hi:[1,0]
    v_pk_mul_f32 v[136:137], v[136:137], v[144:145] op_sel_hi:[1,0]
    v_pk_mul_f32 v[138:139], v[138:139], v[144:145] op_sel_hi:[1,0]
    v_pk_mul_f32 v[140:141], v[140:141], v[144:145] op_sel_hi:[1,0]
    v_pk_mul_f32 v[142:143], v[142:143], v[144:145] op_sel_hi:[1,0]
    v_cvt_pk_bf16_f32 v176, v120, v121
    v_cvt_pk_bf16_f32 v177, v122, v123
    v_cvt_pk_bf16_f32 v178, v124, v125
    v_cvt_pk_bf16_f32 v179, v126, v127
    v_cvt_pk_bf16_f32 v180, v136, v137
    v_cvt_pk_bf16_f32 v181, v138, v139
    v_cvt_pk_bf16_f32 v182, v140, v141
    v_cvt_pk_bf16_f32 v183, v142, v143
    s_waitcnt lgkmcnt(0)
    s_nop 1
    v_mfma_f32_32x32x16_bf16 v[24:39], v[168:171], v[176:179], v[24:39]
    v_mfma_f32_32x32x16_bf16 v[40:55], v[168:171], v[180:183], v[40:55]
    v_mfma_f32_32x32x16_bf16 v[56:71], v[172:175], v[176:179], v[56:71]
    v_mfma_f32_32x32x16_bf16 v[72:87], v[172:175], v[180:183], v[72:87]
    s_barrier
    s_lshl_b32 s44, s24, 12
    s_add_u32 s44, s44, 73728
    v_add_u32 v6, s44, v2
    s_nop 7
    s_nop 3
    ds_write_b128 v6, v[24:27] offset:0
    ds_write_b128 v6, v[28:31] offset:1024
    ds_write_b128 v6, v[32:35] offset:2048
    ds_write_b128 v6, v[36:39] offset:3072
    ds_write_b128 v6, v[40:43] offset:16384
    ds_write_b128 v6, v[44:47] offset:17408
    ds_write_b128 v6, v[48:51] offset:18432
    ds_write_b128 v6, v[52:55] offset:19456
    ds_write_b128 v6, v[56:59] offset:32768
    ds_write_b128 v6, v[60:63] offset:33792
    ds_write_b128 v6, v[64:67] offset:34816
    ds_write_b128 v6, v[68:71] offset:35840
    ds_write_b128 v6, v[72:75] offset:49152
    ds_write_b128 v6, v[76:79] offset:50176
    ds_write_b128 v6, v[80:83] offset:51200
    ds_write_b128 v6, v[84:87] offset:52224
    s_waitcnt lgkmcnt(0)
    s_barrier
    s_lshl_b32 s44, s24, 14
    s_add_u32 s44, s44, 73728
    v_add_u32 v6, s44, v2
    ds_read_b128 v[24:27], v6 offset:0
    ds_read_b128 v[28:31], v6 offset:1024
    ds_read_b128 v[32:35], v6 offset:2048
    ds_read_b128 v[36:39], v6 offset:3072
    ds_read_b128 v[40:43], v6 offset:4096
    ds_read_b128 v[44:47], v6 offset:5120
    ds_read_b128 v[48:51], v6 offset:6144
    ds_read_b128 v[52:55], v6 offset:7168
    ds_read_b128 v[56:59], v6 offset:8192
    ds_read_b128 v[60:63], v6 offset:9216
    ds_read_b128 v[64:67], v6 offset:10240
    ds_read_b128 v[68:71], v6 offset:11264
    ds_read_b128 v[72:75], v6 offset:12288
    ds_read_b128 v[76:79], v6 offset:13312
    ds_read_b128 v[80:83], v6 offset:14336
    ds_read_b128 v[84:87], v6 offset:15360
    s_waitcnt vmcnt(0) lgkmcnt(0)
    v_pk_add_f32 v[24:25], v[24:25], v[40:41]
    v_pk_add_f32 v[56:57], v[56:57], v[72:73]
    v_pk_add_f32 v[26:27], v[26:27], v[42:43]
    v_pk_add_f32 v[58:59], v[58:59], v[74:75]
    v_pk_add_f32 v[28:29], v[28:29], v[44:45]
    v_pk_add_f32 v[60:61], v[60:61], v[76:77]
    v_pk_add_f32 v[30:31], v[30:31], v[46:47]
    v_pk_add_f32 v[62:63], v[62:63], v[78:79]
    v_pk_add_f32 v[32:33], v[32:33], v[48:49]
    v_pk_add_f32 v[64:65], v[64:65], v[80:81]
    v_pk_add_f32 v[34:35], v[34:35], v[50:51]
    v_pk_add_f32 v[66:67], v[66:67], v[82:83]
    v_pk_add_f32 v[36:37], v[36:37], v[52:53]
    v_pk_add_f32 v[68:69], v[68:69], v[84:85]
    v_pk_add_f32 v[38:39], v[38:39], v[54:55]
    v_pk_add_f32 v[70:71], v[70:71], v[86:87]
    v_pk_add_f32 v[24:25], v[24:25], v[56:57]
    v_pk_add_f32 v[26:27], v[26:27], v[58:59]
    v_pk_add_f32 v[28:29], v[28:29], v[60:61]
    v_pk_add_f32 v[30:31], v[30:31], v[62:63]
    v_pk_add_f32 v[32:33], v[32:33], v[64:65]
    v_pk_add_f32 v[34:35], v[34:35], v[66:67]
    v_pk_add_f32 v[36:37], v[36:37], v[68:69]
    v_pk_add_f32 v[38:39], v[38:39], v[70:71]
    v_lshlrev_b32 v8, 16, v16
    v_and_b32 v9, 0xffff0000, v16
    v_pk_add_f32 v[24:25], v[24:25], v[8:9]
    v_cvt_pk_bf16_f32 v16, v24, v25
    v_lshlrev_b32 v8, 16, v17
    v_and_b32 v9, 0xffff0000, v17
    v_pk_add_f32 v[26:27], v[26:27], v[8:9]
    v_cvt_pk_bf16_f32 v17, v26, v27
    v_lshlrev_b32 v8, 16, v18
    v_and_b32 v9, 0xffff0000, v18
    v_pk_add_f32 v[28:29], v[28:29], v[8:9]
    v_cvt_pk_bf16_f32 v18, v28, v29
    v_lshlrev_b32 v8, 16, v19
    v_and_b32 v9, 0xffff0000, v19
    v_pk_add_f32 v[30:31], v[30:31], v[8:9]
    v_cvt_pk_bf16_f32 v19, v30, v31
    v_lshlrev_b32 v8, 16, v20
    v_and_b32 v9, 0xffff0000, v20
    v_pk_add_f32 v[32:33], v[32:33], v[8:9]
    v_cvt_pk_bf16_f32 v20, v32, v33
    v_lshlrev_b32 v8, 16, v21
    v_and_b32 v9, 0xffff0000, v21
    v_pk_add_f32 v[34:35], v[34:35], v[8:9]
    v_cvt_pk_bf16_f32 v21, v34, v35
    v_lshlrev_b32 v8, 16, v22
    v_and_b32 v9, 0xffff0000, v22
    v_pk_add_f32 v[36:37], v[36:37], v[8:9]
    v_cvt_pk_bf16_f32 v22, v36, v37
    v_lshlrev_b32 v8, 16, v23
    v_and_b32 v9, 0xffff0000, v23
    v_pk_add_f32 v[38:39], v[38:39], v[8:9]
    v_cvt_pk_bf16_f32 v23, v38, v39
    s_lshl_b32 s44, s50, 5
    s_lshl_b32 s45, s51, 1
    s_add_u32 s44, s44, s45
    s_lshl_b32 s44, s44, 10
    s_add_u32 s44, s44, 5242880
    buffer_store_dwordx4 v[16:19], v2, s[28:31], s44 offen offset:0 sc1
    buffer_store_dwordx4 v[20:23], v2, s[28:31], s44 offen offset:1024 sc1
    v_lshlrev_b32 v8, 16, v16
    v_and_b32 v9, 0xffff0000, v16
    v_mov_b32 v10, v8
    v_mov_b32 v11, v9
    v_pk_mul_f32 v[12:13], v[8:9], v[8:9]
    v_lshlrev_b32 v8, 16, v17
    v_and_b32 v9, 0xffff0000, v17
    v_pk_add_f32 v[10:11], v[10:11], v[8:9]
    v_pk_fma_f32 v[12:13], v[8:9], v[8:9], v[12:13]
    v_lshlrev_b32 v8, 16, v18
    v_and_b32 v9, 0xffff0000, v18
    v_pk_add_f32 v[10:11], v[10:11], v[8:9]
    v_pk_fma_f32 v[12:13], v[8:9], v[8:9], v[12:13]
    v_lshlrev_b32 v8, 16, v19
    v_and_b32 v9, 0xffff0000, v19
    v_pk_add_f32 v[10:11], v[10:11], v[8:9]
    v_pk_fma_f32 v[12:13], v[8:9], v[8:9], v[12:13]
    v_lshlrev_b32 v8, 16, v20
    v_and_b32 v9, 0xffff0000, v20
    v_pk_add_f32 v[10:11], v[10:11], v[8:9]
    v_pk_fma_f32 v[12:13], v[8:9], v[8:9], v[12:13]
    v_lshlrev_b32 v8, 16, v21
    v_and_b32 v9, 0xffff0000, v21
    v_pk_add_f32 v[10:11], v[10:11], v[8:9]
    v_pk_fma_f32 v[12:13], v[8:9], v[8:9], v[12:13]
    v_lshlrev_b32 v8, 16, v22
    v_and_b32 v9, 0xffff0000, v22
    v_pk_add_f32 v[10:11], v[10:11], v[8:9]
    v_pk_fma_f32 v[12:13], v[8:9], v[8:9], v[12:13]
    v_lshlrev_b32 v8, 16, v23
    v_and_b32 v9, 0xffff0000, v23
    v_pk_add_f32 v[10:11], v[10:11], v[8:9]
    v_pk_fma_f32 v[12:13], v[8:9], v[8:9], v[12:13]
    v_add_f32 v6, v10, v11
    v_add_f32 v7, v12, v13
    v_mov_b32 v9, v6
    s_nop 1
    v_permlane32_swap_b32 v6, v9
    s_nop 1
    v_add_f32 v6, v6, v9
    v_mov_b32 v10, v7
    s_nop 1
    v_permlane32_swap_b32 v7, v10
    s_nop 1
    v_add_f32 v7, v7, v10
    s_lshl_b32 s44, s50, 8
    s_lshl_b32 s45, s51, 14
    s_add_u32 s44, s44, s45
    s_add_u32 s44, s44, 7340032
    v_and_b32 v8, 31, v0
    v_lshlrev_b32 v8, 3, v8
    v_cmp_gt_u32 vcc, 32, v0
    s_and_saveexec_b64 s[48:49], vcc
    buffer_store_dwordx2 v[6:7], v8, s[28:31], s44 offen sc1
    s_mov_b64 exec, s[48:49]
P2_DONE:
    s_and_b32 s44, s2, 7
    s_lshr_b32 s45, s2, 3
    s_and_b32 s56, s44, 3
    s_lshl_b32 s56, s56, 2
    s_and_b32 s46, s45, 3
    s_add_u32 s56, s56, s46
    s_lshr_b32 s57, s44, 2
    s_mul_i32 s57, s57, 7
    s_lshr_b32 s46, s45, 2
    s_add_u32 s57, s57, s46
    s_and_b32 s58, s45, 3
    s_lshl_b32 s58, s58, 1
    s_add_u32 s58, s58, s46
    s_and_b32 s58, s58, 7
    s_lshl_b32 s55, s44, 2
    s_and_b32 s46, s45, 3
    s_add_u32 s55, s55, s46
    s_and_b32 s46, s55, 1
    s_lshr_b32 s55, s55, 1
    s_lshl_b32 s55, s55, 4
    s_add_u32 s55, s55, s46
    s_lshr_b32 s46, s45, 2
    s_lshl_b32 s46, s46, 1
    s_add_u32 s55, s55, s46
    s_cmp_ge_u32 s24, 4
    s_cbranch_scc0 P3_CONS
    s_barrier
    s_barrier
    s_cmp_ge_u32 s2, 224
    s_cbranch_scc1 P3_DONE
    v_lshlrev_b32 v3, 4, v0
    v_lshrrev_b32 v24, 4, v0
    v_bfe_u32 v25, v0, 1, 3
    v_xor_b32 v25, v25, v24
    v_mul_u32_u24 v26, 3584, v24
    v_and_b32 v27, 1, v0
    v_lshl_add_u32 v26, v27, 4, v26
    v_lshl_add_u32 v4, v25, 5, v26
    v_xor_b32 v25, 4, v25
    v_lshl_add_u32 v5, v25, 5, v26
    s_mov_b32 s32, s12
    s_and_b32 s33, s13, 0xffff
    s_mov_b32 s34, 1835008
    s_mov_b32 s35, 0x20000
    s_mov_b32 s36, s14
    s_and_b32 s37, s15, 0xffff
    s_mov_b32 s38, 1835008
    s_mov_b32 s39, 0x20000
    s_lshl_b32 s59, s56, 2
    s_add_u32 s59, s59, s25
    s_lshl_b32 s59, s59, 15
    s_add_u32 s59, s59, 5242880
    s_mul_i32 s60, s25, 57344
    s_lshl_b32 s46, s57, 8
    s_add_u32 s60, s60, s46
    s_lshl_b32 s61, s25, 12
    s_lshl_b32 s62, s25, 12
    s_add_u32 s62, s62, 16384
    s_mov_b32 s63, s58
    s_mov_b32 s3, s58
    s_mul_i32 s50, s3, 229376
    s_add_u32 s50, s50, s60
    s_add_u32 s3, s3, 1
    s_and_b32 s3, s3, 7
    s_add_u32 m0, s62, 8192
    s_nop 0
    buffer_load_dwordx4 v4, s[32:35], s50 offen lds
    s_add_u32 m0, s62, 24576
    s_nop 0
    buffer_load_dwordx4 v5, s[36:39], s50 offen lds
    s_add_u32 s50, s50, 14336
    s_add_u32 m0, s62, 9216
    s_nop 0
    buffer_load_dwordx4 v4, s[32:35], s50 offen lds
    s_add_u32 m0, s62, 25600
    s_nop 0
    buffer_load_dwordx4 v5, s[36:39], s50 offen lds
    s_add_u32 s50, s50, 14336
    s_add_u32 m0, s62, 10240
    s_nop 0
    buffer_load_dwordx4 v4, s[32:35], s50 offen lds
    s_add_u32 m0, s62, 26624
    s_nop 0
    buffer_load_dwordx4 v5, s[36:39], s50 offen lds
    s_add_u32 s50, s50, 14336
    s_add_u32 m0, s62, 11264
    s_nop 0
    buffer_load_dwordx4 v4, s[32:35], s50 offen lds
    s_add_u32 m0, s62, 27648
    s_nop 0
    buffer_load_dwordx4 v5, s[36:39], s50 offen lds
    s_mul_i32 s50, s3, 229376
    s_add_u32 s50, s50, s60
    s_add_u32 s3, s3, 1
    s_and_b32 s3, s3, 7
    s_add_u32 m0, s62, 57344
    s_nop 0
    buffer_load_dwordx4 v4, s[32:35], s50 offen lds
    s_add_u32 m0, s62, 73728
    s_nop 0
    buffer_load_dwordx4 v5, s[36:39], s50 offen lds
    s_add_u32 s50, s50, 14336
    s_add_u32 m0, s62, 58368
    s_nop 0
    buffer_load_dwordx4 v4, s[32:35], s50 offen lds
    s_add_u32 m0, s62, 74752
    s_nop 0
    buffer_load_dwordx4 v5, s[36:39], s50 offen lds
    s_add_u32 s50, s50, 14336
    s_add_u32 m0, s62, 59392
    s_nop 0
    buffer_load_dwordx4 v4, s[32:35], s50 offen lds
    s_add_u32 m0, s62, 75776
    s_nop 0
    buffer_load_dwordx4 v5, s[36:39], s50 offen lds
    s_add_u32 s50, s50, 14336
    s_add_u32 m0, s62, 60416
    s_nop 0
    buffer_load_dwordx4 v4, s[32:35], s50 offen lds
    s_add_u32 m0, s62, 76800
    s_nop 0
    buffer_load_dwordx4 v5, s[36:39], s50 offen lds
    s_mul_i32 s50, s3, 229376
    s_add_u32 s50, s50, s60
    s_add_u32 s3, s3, 1
    s_and_b32 s3, s3, 7
    s_add_u32 m0, s62, 106496
    s_nop 0
    buffer_load_dwordx4 v4, s[32:35], s50 offen lds
    s_add_u32 m0, s62, 122880
    s_nop 0
    buffer_load_dwordx4 v5, s[36:39], s50 offen lds
    s_add_u32 s50, s50, 14336
    s_add_u32 m0, s62, 107520
    s_nop 0
    buffer_load_dwordx4 v4, s[32:35], s50 offen lds
    s_add_u32 m0, s62, 123904
    s_nop 0
    buffer_load_dwordx4 v5, s[36:39], s50 offen lds
    s_add_u32 s50, s50, 14336
    s_add_u32 m0, s62, 108544
    s_nop 0
    buffer_load_dwordx4 v4, s[32:35], s50 offen lds
    s_add_u32 m0, s62, 124928
    s_nop 0
    buffer_load_dwordx4 v5, s[36:39], s50 offen lds
    s_add_u32 s50, s50, 14336
    s_add_u32 m0, s62, 109568
    s_nop 0
    buffer_load_dwordx4 v4, s[32:35], s50 offen lds
    s_add_u32 m0, s62, 125952
    s_nop 0
    buffer_load_dwordx4 v5, s[36:39], s50 offen lds
    s_barrier
    s_lshl_b32 s27, s63, 12
    s_add_u32 s27, s27, s59
    s_add_u32 m0, s61, 8192
    s_add_u32 s63, s63, 1
    buffer_load_dwordx4 v3, s[28:31], s27 offen offset:0 sc1 lds
    buffer_load_dwordx4 v3, s[28:31], s27 offen offset:1024 sc1 lds
    buffer_load_dwordx4 v3, s[28:31], s27 offen offset:2048 sc1 lds
    buffer_load_dwordx4 v3, s[28:31], s27 offen offset:3072 sc1 lds
    s_and_b32 s63, s63, 7
    s_lshl_b32 s27, s63, 12
    s_add_u32 s27, s27, s59
    s_add_u32 m0, s61, 57344
    s_add_u32 s63, s63, 1
    buffer_load_dwordx4 v3, s[28:31], s27 offen offset:0 sc1 lds
    buffer_load_dwordx4 v3, s[28:31], s27 offen offset:1024 sc1 lds
    buffer_load_dwordx4 v3, s[28:31], s27 offen offset:2048 sc1 lds
    buffer_load_dwordx4 v3, s[28:31], s27 offen offset:3072 sc1 lds
    s_and_b32 s63, s63, 7
    s_waitcnt vmcnt(4)
    s_barrier
    s_lshl_b32 s27, s63, 12
    s_add_u32 s27, s27, s59
    s_add_u32 m0, s61, 106496
    s_add_u32 s63, s63, 1
    buffer_load_dwordx4 v3, s[28:31], s27 offen offset:0 sc1 lds
    buffer_load_dwordx4 v3, s[28:31], s27 offen offset:1024 sc1 lds
    buffer_load_dwordx4 v3, s[28:31], s27 offen offset:2048 sc1 lds
    buffer_load_dwordx4 v3, s[28:31], s27 offen offset:3072 sc1 lds
    s_and_b32 s63, s63, 7
    v_and_b32 v24, 15, v0
    v_lshlrev_b32 v24, 4, v24
    v_lshrrev_b32 v25, 4, v0
    v_lshl_add_u32 v24, v25, 16, v24
    s_lshl_b32 s44, s56, 2
    s_add_u32 s44, s44, s25
    s_lshl_b32 s44, s44, 8
    s_add_u32 s44, s44, 7340032
    buffer_load_dwordx4 v[8:11], v24, s[28:31], s44 offen sc1
    s_add_u32 s44, s44, 16384
    buffer_load_dwordx4 v[12:15], v24, s[28:31], s44 offen sc1
    s_add_u32 s44, s44, 16384
    buffer_load_dwordx4 v[16:19], v24, s[28:31], s44 offen sc1
    s_add_u32 s44, s44, 16384
    buffer_load_dwordx4 v[20:23], v24, s[28:31], s44 offen sc1
    v_and_b32 v26, 31, v0
    v_lshlrev_b32 v26, 4, v26
    v_lshrrev_b32 v27, 5, v0
    v_mul_u32_u24 v27, 7168, v27
    v_add_u32 v26, v26, v27
    s_mul_i32 s45, s25, 57344
    s_lshl_b32 s46, s57, 9
    s_add_u32 s45, s45, s46
    s_add_u32 s45, s45, 7864320
    buffer_load_dwordx4 v[32:35], v26, s[28:31], s45 offen sc1
    s_add_u32 s45, s45, 14336
    buffer_load_dwordx4 v[36:39], v26, s[28:31], s45 offen sc1
    s_add_u32 s45, s45, 14336
    buffer_load_dwordx4 v[40:43], v26, s[28:31], s45 offen sc1
    s_add_u32 s45, s45, 14336
    buffer_load_dwordx4 v[44:47], v26, s[28:31], s45 offen sc1
    s_waitcnt vmcnt(12)
    s_barrier
    s_lshl_b32 s27, s63, 12
    s_add_u32 s27, s27, s59
    s_add_u32 m0, s61, 8192
    s_add_u32 s63, s63, 1
    buffer_load_dwordx4 v3, s[28:31], s27 offen offset:0 sc1 lds
    buffer_load_dwordx4 v3, s[28:31], s27 offen offset:1024 sc1 lds
    buffer_load_dwordx4 v3, s[28:31], s27 offen offset:2048 sc1 lds
    buffer_load_dwordx4 v3, s[28:31], s27 offen offset:3072 sc1 lds
    s_and_b32 s63, s63, 7
    s_mul_i32 s50, s3, 229376
    s_add_u32 s50, s50, s60
    s_add_u32 s3, s3, 1
    s_and_b32 s3, s3, 7
    s_add_u32 m0, s62, 8192
    s_nop 0
    buffer_load_dwordx4 v4, s[32:35], s50 offen lds
    s_add_u32 m0, s62, 24576
    s_nop 0
    buffer_load_dwordx4 v5, s[36:39], s50 offen lds
    s_add_u32 s50, s50, 14336
    s_add_u32 m0, s62, 9216
    s_nop 0
    buffer_load_dwordx4 v4, s[32:35], s50 offen lds
    s_add_u32 m0, s62, 25600
    s_nop 0
    buffer_load_dwordx4 v5, s[36:39], s50 offen lds
    s_add_u32 s50, s50, 14336
    s_add_u32 m0, s62, 10240
    s_nop 0
    buffer_load_dwordx4 v4, s[32:35], s50 offen lds
    s_add_u32 m0, s62, 26624
    s_nop 0
    buffer_load_dwordx4 v5, s[36:39], s50 offen lds
    s_add_u32 s50, s50, 14336
    s_add_u32 m0, s62, 11264
    s_nop 0
    buffer_load_dwordx4 v4, s[32:35], s50 offen lds
    s_add_u32 m0, s62, 27648
    s_nop 0
    buffer_load_dwordx4 v5, s[36:39], s50 offen lds
    s_waitcnt vmcnt(20)
    s_barrier
    s_lshl_b32 s27, s63, 12
    s_add_u32 s27, s27, s59
    s_add_u32 m0, s61, 57344
    s_add_u32 s63, s63, 1
    buffer_load_dwordx4 v3, s[28:31], s27 offen offset:0 sc1 lds
    buffer_load_dwordx4 v3, s[28:31], s27 offen offset:1024 sc1 lds
    buffer_load_dwordx4 v3, s[28:31], s27 offen offset:2048 sc1 lds
    buffer_load_dwordx4 v3, s[28:31], s27 offen offset:3072 sc1 lds
    s_and_b32 s63, s63, 7
    s_mul_i32 s50, s3, 229376
    s_add_u32 s50, s50, s60
    s_add_u32 s3, s3, 1
    s_and_b32 s3, s3, 7
    s_add_u32 m0, s62, 57344
    s_nop 0
    buffer_load_dwordx4 v4, s[32:35], s50 offen lds
    s_add_u32 m0, s62, 73728
    s_nop 0
    buffer_load_dwordx4 v5, s[36:39], s50 offen lds
    s_add_u32 s50, s50, 14336
    s_add_u32 m0, s62, 58368
    s_nop 0
    buffer_load_dwordx4 v4, s[32:35], s50 offen lds
    s_add_u32 m0, s62, 74752
    s_nop 0
    buffer_load_dwordx4 v5, s[36:39], s50 offen lds
    s_add_u32 s50, s50, 14336
    s_add_u32 m0, s62, 59392
    s_nop 0
    buffer_load_dwordx4 v4, s[32:35], s50 offen lds
    s_add_u32 m0, s62, 75776
    s_nop 0
    buffer_load_dwordx4 v5, s[36:39], s50 offen lds
    s_add_u32 s50, s50, 14336
    s_add_u32 m0, s62, 60416
    s_nop 0
    buffer_load_dwordx4 v4, s[32:35], s50 offen lds
    s_add_u32 m0, s62, 76800
    s_nop 0
    buffer_load_dwordx4 v5, s[36:39], s50 offen lds
    s_waitcnt vmcnt(12)
    s_barrier
    v_add_f32 v32, v32, v36
    v_add_f32 v33, v33, v37
    v_add_f32 v34, v34, v38
    v_add_f32 v35, v35, v39
    v_add_f32 v32, v32, v40
    v_add_f32 v33, v33, v41
    v_add_f32 v34, v34, v42
    v_add_f32 v35, v35, v43
    v_add_f32 v32, v32, v44
    v_add_f32 v33, v33, v45
    v_add_f32 v34, v34, v46
    v_add_f32 v35, v35, v47
    v_lshlrev_b32 v26, 4, v0
    s_lshl_b32 s45, s25, 10
    v_add_u32 v26, s45, v26
    ds_write_b128 v26, v[32:35] offset:1024
    v_add_f32 v8, v8, v12
    v_add_f32 v9, v9, v13
    v_add_f32 v10, v10, v14
    v_add_f32 v11, v11, v15
    v_add_f32 v8, v8, v16
    v_add_f32 v9, v9, v17
    v_add_f32 v10, v10, v18
    v_add_f32 v11, v11, v19
    v_add_f32 v8, v8, v20
    v_add_f32 v9, v9, v21
    v_add_f32 v10, v10, v22
    v_add_f32 v11, v11, v23
    s_lshl_b32 s27, s63, 12
    s_add_u32 s27, s27, s59
    s_add_u32 m0, s61, 106496
    s_add_u32 s63, s63, 1
    buffer_load_dwordx4 v3, s[28:31], s27 offen offset:0 sc1 lds
    buffer_load_dwordx4 v3, s[28:31], s27 offen offset:1024 sc1 lds
    buffer_load_dwordx4 v3, s[28:31], s27 offen offset:2048 sc1 lds
    buffer_load_dwordx4 v3, s[28:31], s27 offen offset:3072 sc1 lds
    s_and_b32 s63, s63, 7
    s_mul_i32 s50, s3, 229376
    s_add_u32 s50, s50, s60
    s_add_u32 s3, s3, 1
    s_and_b32 s3, s3, 7
    s_add_u32 m0, s62, 106496
    s_nop 0
    buffer_load_dwordx4 v4, s[32:35], s50 offen lds
    s_add_u32 m0, s62, 122880
    s_nop 0
    buffer_load_dwordx4 v5, s[36:39], s50 offen lds
    s_add_u32 s50, s50, 14336
    s_add_u32 m0, s62, 107520
    s_nop 0
    buffer_load_dwordx4 v4, s[32:35], s50 offen lds
    s_add_u32 m0, s62, 123904
    s_nop 0
    buffer_load_dwordx4 v5, s[36:39], s50 offen lds
    s_add_u32 s50, s50, 14336
    s_add_u32 m0, s62, 108544
    s_nop 0
    buffer_load_dwordx4 v4, s[32:35], s50 offen lds
    s_add_u32 m0, s62, 124928
    s_nop 0
    buffer_load_dwordx4 v5, s[36:39], s50 offen lds
    s_add_u32 s50, s50, 14336
    s_add_u32 m0, s62, 109568
    s_nop 0
    buffer_load_dwordx4 v4, s[32:35], s50 offen lds
    s_add_u32 m0, s62, 125952
    s_nop 0
    buffer_load_dwordx4 v5, s[36:39], s50 offen lds
    s_waitcnt vmcnt(12)
    s_barrier
    v_mov_b32 v12, v8
    v_mov_b32 v13, v9
    v_mov_b32 v14, v10
    v_mov_b32 v15, v11
    s_nop 1
    v_permlane16_swap_b32 v8, v12
    v_permlane16_swap_b32 v9, v13
    v_permlane16_swap_b32 v10, v14
    v_permlane16_swap_b32 v11, v15
    s_nop 1
    v_add_f32 v8, v8, v12
    v_add_f32 v9, v9, v13
    v_add_f32 v10, v10, v14
    v_add_f32 v11, v11, v15
    v_mov_b32 v12, v8
    v_mov_b32 v13, v9
    v_mov_b32 v14, v10
    v_mov_b32 v15, v11
    s_nop 1
    v_permlane32_swap_b32 v8, v12
    v_permlane32_swap_b32 v9, v13
    v_permlane32_swap_b32 v10, v14
    v_permlane32_swap_b32 v11, v15
    s_nop 1
    v_add_f32 v8, v8, v12
    v_add_f32 v9, v9, v13
    v_add_f32 v10, v10, v14
    v_add_f32 v11, v11, v15
    s_lshl_b32 s27, s63, 12
    s_add_u32 s27, s27, s59
    s_add_u32 m0, s61, 8192
    s_add_u32 s63, s63, 1
    buffer_load_dwordx4 v3, s[28:31], s27 offen offset:0 sc1 lds
    buffer_load_dwordx4 v3, s[28:31], s27 offen offset:1024 sc1 lds
    buffer_load_dwordx4 v3, s[28:31], s27 offen offset:2048 sc1 lds
    buffer_load_dwordx4 v3, s[28:31], s27 offen offset:3072 sc1 lds
    s_and_b32 s63, s63, 7
    s_mul_i32 s50, s3, 229376
    s_add_u32 s50, s50, s60
    s_add_u32 s3, s3, 1
    s_and_b32 s3, s3, 7
    s_add_u32 m0, s62, 8192
    s_nop 0
    buffer_load_dwordx4 v4, s[32:35], s50 offen lds
    s_add_u32 m0, s62, 24576
    s_nop 0
    buffer_load_dwordx4 v5, s[36:39], s50 offen lds
    s_add_u32 s50, s50, 14336
    s_add_u32 m0, s62, 9216
    s_nop 0
    buffer_load_dwordx4 v4, s[32:35], s50 offen lds
    s_add_u32 m0, s62, 25600
    s_nop 0
    buffer_load_dwordx4 v5, s[36:39], s50 offen lds
    s_add_u32 s50, s50, 14336
    s_add_u32 m0, s62, 10240
    s_nop 0
    buffer_load_dwordx4 v4, s[32:35], s50 offen lds
    s_add_u32 m0, s62, 26624
    s_nop 0
    buffer_load_dwordx4 v5, s[36:39], s50 offen lds
    s_add_u32 s50, s50, 14336
    s_add_u32 m0, s62, 11264
    s_nop 0
    buffer_load_dwordx4 v4, s[32:35], s50 offen lds
    s_add_u32 m0, s62, 27648
    s_nop 0
    buffer_load_dwordx4 v5, s[36:39], s50 offen lds
    s_waitcnt vmcnt(12)
    s_barrier
    v_mul_f32 v8, 0x3b000000, v8
    v_mul_f32 v9, 0x3b000000, v9
    v_fma_f32 v9, -v8, v8, v9
    v_max_f32 v9, 0, v9
    v_add_f32 v9, 0x3727c5ac, v9
    v_rsq_f32 v9, v9
    s_nop 0
    v_mul_f32 v10, 0x3b000000, v10
    v_mul_f32 v11, 0x3b000000, v11
    v_fma_f32 v11, -v10, v10, v11
    v_max_f32 v11, 0, v11
    v_add_f32 v11, 0x3727c5ac, v11
    v_rsq_f32 v11, v11
    s_nop 0
    v_and_b32 v24, 15, v0
    v_lshlrev_b32 v24, 4, v24
    s_lshl_b32 s46, s25, 8
    v_add_u32 v24, s46, v24
    ds_write_b128 v24, v[8:11] offset:0
    s_waitcnt lgkmcnt(0)
    s_lshl_b32 s27, s63, 12
    s_add_u32 s27, s27, s59
    s_add_u32 m0, s61, 57344
    s_add_u32 s63, s63, 1
    buffer_load_dwordx4 v3, s[28:31], s27 offen offset:0 sc1 lds
    buffer_load_dwordx4 v3, s[28:31], s27 offen offset:1024 sc1 lds
    buffer_load_dwordx4 v3, s[28:31], s27 offen offset:2048 sc1 lds
    buffer_load_dwordx4 v3, s[28:31], s27 offen offset:3072 sc1 lds
    s_and_b32 s63, s63, 7
    s_mul_i32 s50, s3, 229376
    s_add_u32 s50, s50, s60
    s_add_u32 s3, s3, 1
    s_and_b32 s3, s3, 7
    s_add_u32 m0, s62, 57344
    s_nop 0
    buffer_load_dwordx4 v4, s[32:35], s50 offen lds
    s_add_u32 m0, s62, 73728
    s_nop 0
    buffer_load_dwordx4 v5, s[36:39], s50 offen lds
    s_add_u32 s50, s50, 14336
    s_add_u32 m0, s62, 58368
    s_nop 0
    buffer_load_dwordx4 v4, s[32:35], s50 offen lds
    s_add_u32 m0, s62, 74752
    s_nop 0
    buffer_load_dwordx4 v5, s[36:39], s50 offen lds
    s_add_u32 s50, s50, 14336
    s_add_u32 m0, s62, 59392
    s_nop 0
    buffer_load_dwordx4 v4, s[32:35], s50 offen lds
    s_add_u32 m0, s62, 75776
    s_nop 0
    buffer_load_dwordx4 v5, s[36:39], s50 offen lds
    s_add_u32 s50, s50, 14336
    s_add_u32 m0, s62, 60416
    s_nop 0
    buffer_load_dwordx4 v4, s[32:35], s50 offen lds
    s_add_u32 m0, s62, 76800
    s_nop 0
    buffer_load_dwordx4 v5, s[36:39], s50 offen lds
    s_mov_b32 s52, s16
    s_and_b32 s53, s17, 0xffff
    s_mov_b32 s54, 1835008
    s_mov_b32 s55, 0x20000
    v_lshlrev_b32 v28, 7, v0
    s_lshr_b32 s45, s2, 3
    s_lshl_b32 s45, s45, 2
    s_add_u32 s45, s45, s25
    s_mul_i32 s46, s45, 16384
    buffer_load_dword v255, v28, s[52:55], s46 offen
    s_add_u32 s46, s46, 8192
    buffer_load_dword v255, v28, s[52:55], s46 offen
    s_waitcnt vmcnt(14)
    s_barrier
    s_waitcnt vmcnt(2)
    s_barrier
    s_branch P3_DONE
P3_CONS:
    s_waitcnt vmcnt(0)
    s_barrier
    s_cmp_eq_u32 s24, 0
    s_cbranch_scc0 SIG2C
    s_lshl_b32 s44, s55, 7
    s_add_u32 s44, s44, 8159232
    v_mov_b32 v188, 0
    v_mov_b32 v189, s26
    v_cmp_eq_u32 vcc, 0, v0
    s_and_saveexec_b64 s[48:49], vcc
    buffer_store_dword v189, v188, s[28:31], s44 offen sc1
    s_mov_b64 exec, s[48:49]
SIG2C:
    s_barrier
    s_cmp_ge_u32 s2, 224
    s_cbranch_scc1 P3_DONE
    s_and_b32 s59, s24, 1
    s_lshr_b32 s60, s24, 1
    v_lshlrev_b32 v186, 4, v0
    s_lshl_b32 s44, s59, 13
    s_add_u32 s44, s44, 8192
    v_add_u32 v180, s44, v186
    v_bfe_u32 v188, v0, 2, 2
    v_lshrrev_b32 v189, 5, v0
    v_lshl_add_u32 v189, v189, 3, v188
    v_lshlrev_b32 v189, 8, v189
    v_bfe_u32 v190, v0, 1, 1
    v_lshl_add_u32 v189, v190, 14, v189
    v_lshl_or_b32 v190, v190, 2, v188
    v_lshl_add_u32 v189, v190, 5, v189
    v_and_b32 v190, 1, v0
    v_lshl_add_u32 v189, v190, 4, v189
    v_bfe_u32 v190, v0, 4, 1
    v_lshl_add_u32 v189, v190, 3, v189
    s_lshl_b32 s44, s60, 2
    s_add_u32 s45, s44, 0
    s_lshl_b32 s45, s45, 5
    v_xor_b32 v182, s45, v189
    v_add_u32 v182, 24576, v182
    s_add_u32 s45, s44, 1
    s_lshl_b32 s45, s45, 5
    v_xor_b32 v183, s45, v189
    v_add_u32 v183, 24576, v183
    s_add_u32 s45, s44, 2
    s_lshl_b32 s45, s45, 5
    v_xor_b32 v184, s45, v189
    v_add_u32 v184, 24576, v184
    s_add_u32 s45, s44, 3
    s_lshl_b32 s45, s45, 5
    v_xor_b32 v185, s45, v189
    v_add_u32 v185, 24576, v185
    v_mov_b32 v4, 0
    v_mov_b32 v5, 0
    v_mov_b32 v6, 0
    v_mov_b32 v7, 0
    v_mov_b32 v8, 0
    v_mov_b32 v9, 0
    v_mov_b32 v10, 0
    v_mov_b32 v11, 0
    v_mov_b32 v12, 0
    v_mov_b32 v13, 0
    v_mov_b32 v14, 0
    v_mov_b32 v15, 0
    v_mov_b32 v16, 0
    v_mov_b32 v17, 0
    v_mov_b32 v18, 0
    v_mov_b32 v19, 0
    v_mov_b32 v20, 0
    v_mov_b32 v21, 0
    v_mov_b32 v22, 0
    v_mov_b32 v23, 0
    v_mov_b32 v24, 0
    v_mov_b32 v25, 0
    v_mov_b32 v26, 0
    v_mov_b32 v27, 0
    v_mov_b32 v28, 0
    v_mov_b32 v29, 0
    v_mov_b32 v30, 0
    v_mov_b32 v31, 0
    v_mov_b32 v32, 0
    v_mov_b32 v33, 0
    v_mov_b32 v34, 0
    v_mov_b32 v35, 0
    v_mov_b32 v36, 0
    v_mov_b32 v37, 0
    v_mov_b32 v38, 0
    v_mov_b32 v39, 0
    v_mov_b32 v40, 0
    v_mov_b32 v41, 0
    v_mov_b32 v42, 0
    v_mov_b32 v43, 0
    v_mov_b32 v44, 0
    v_mov_b32 v45, 0
    v_mov_b32 v46, 0
    v_mov_b32 v47, 0
    v_mov_b32 v48, 0
    v_mov_b32 v49, 0
    v_mov_b32 v50, 0
    v_mov_b32 v51, 0
    v_mov_b32 v52, 0
    v_mov_b32 v53, 0
    v_mov_b32 v54, 0
    v_mov_b32 v55, 0
    v_mov_b32 v56, 0
    v_mov_b32 v57, 0
    v_mov_b32 v58, 0
    v_mov_b32 v59, 0
    v_mov_b32 v60, 0
    v_mov_b32 v61, 0
    v_mov_b32 v62, 0
    v_mov_b32 v63, 0
    v_mov_b32 v64, 0
    v_mov_b32 v65, 0
    v_mov_b32 v66, 0
    v_mov_b32 v67, 0
    v_mov_b32 v68, 0
    v_mov_b32 v69, 0
    v_mov_b32 v70, 0
    v_mov_b32 v71, 0
    v_mov_b32 v72, 0
    v_mov_b32 v73, 0
    v_mov_b32 v74, 0
    v_mov_b32 v75, 0
    v_mov_b32 v76, 0
    v_mov_b32 v77, 0
    v_mov_b32 v78, 0
    v_mov_b32 v79, 0
    v_mov_b32 v80, 0
    v_mov_b32 v81, 0
    v_mov_b32 v82, 0
    v_mov_b32 v83, 0
    v_mov_b32 v84, 0
    v_mov_b32 v85, 0
    v_mov_b32 v86, 0
    v_mov_b32 v87, 0
    v_mov_b32 v88, 0
    v_mov_b32 v89, 0
    v_mov_b32 v90, 0
    v_mov_b32 v91, 0
    v_mov_b32 v92, 0
    v_mov_b32 v93, 0
    v_mov_b32 v94, 0
    v_mov_b32 v95, 0
    v_mov_b32 v96, 0
    v_mov_b32 v97, 0
    v_mov_b32 v98, 0
    v_mov_b32 v99, 0
    v_mov_b32 v100, 0
    v_mov_b32 v101, 0
    v_mov_b32 v102, 0
    v_mov_b32 v103, 0
    v_mov_b32 v104, 0
    v_mov_b32 v105, 0
    v_mov_b32 v106, 0
    v_mov_b32 v107, 0
    v_mov_b32 v108, 0
    v_mov_b32 v109, 0
    v_mov_b32 v110, 0
    v_mov_b32 v111, 0
    v_mov_b32 v112, 0
    v_mov_b32 v113, 0
    v_mov_b32 v114, 0
    v_mov_b32 v115, 0
    v_mov_b32 v116, 0
    v_mov_b32 v117, 0
    v_mov_b32 v118, 0
    v_mov_b32 v119, 0
    v_mov_b32 v120, 0
    v_mov_b32 v121, 0
    v_mov_b32 v122, 0
    v_mov_b32 v123, 0
    v_mov_b32 v124, 0
    v_mov_b32 v125, 0
    v_mov_b32 v126, 0
    v_mov_b32 v127, 0
    v_mov_b32 v128, 0
    v_mov_b32 v129, 0
    v_mov_b32 v130, 0
    v_mov_b32 v131, 0
    s_cmp_eq_u32 s24, 0
    s_cbranch_scc0 WAI2C
    s_lshl_b32 s46, s56, 11
    s_add_u32 s46, s46, 8159232
    s_add_u32 s44, s22, s46
    s_addc_u32 s45, s23, 0
    s_mov_b32 s54, 0
POL2C:
    s_load_dword s32, s[44:45], 0 glc
    s_load_dword s33, s[44:45], 128 glc
    s_load_dword s34, s[44:45], 256 glc
    s_load_dword s35, s[44:45], 384 glc
    s_load_dword s36, s[44:45], 512 glc
    s_load_dword s37, s[44:45], 640 glc
    s_load_dword s38, s[44:45], 768 glc
    s_load_dword s39, s[44:45], 896 glc
    s_load_dword s40, s[44:45], 1024 glc
    s_load_dword s41, s[44:45], 1152 glc
    s_load_dword s42, s[44:45], 1280 glc
    s_load_dword s43, s[44:45], 1408 glc
    s_load_dword s50, s[44:45], 1536 glc
    s_load_dword s51, s[44:45], 1664 glc
    s_load_dword s52, s[44:45], 1792 glc
    s_load_dword s53, s[44:45], 1920 glc
    s_waitcnt lgkmcnt(0)
    s_xor_b32 s46, s32, s26
    s_xor_b32 s33, s33, s26
    s_or_b32 s46, s46, s33
    s_xor_b32 s34, s34, s26
    s_or_b32 s46, s46, s34
    s_xor_b32 s35, s35, s26
    s_or_b32 s46, s46, s35
    s_xor_b32 s36, s36, s26
    s_or_b32 s46, s46, s36
    s_xor_b32 s37, s37, s26
    s_or_b32 s46, s46, s37
    s_xor_b32 s38, s38, s26
    s_or_b32 s46, s46, s38
    s_xor_b32 s39, s39, s26
    s_or_b32 s46, s46, s39
    s_xor_b32 s40, s40, s26
    s_or_b32 s46, s46, s40
    s_xor_b32 s41, s41, s26
    s_or_b32 s46, s46, s41
    s_xor_b32 s42, s42, s26
    s_or_b32 s46, s46, s42
    s_xor_b32 s43, s43, s26
    s_or_b32 s46, s46, s43
    s_xor_b32 s50, s50, s26
    s_or_b32 s46, s46, s50
    s_xor_b32 s51, s51, s26
    s_or_b32 s46, s46, s51
    s_xor_b32 s52, s52, s26
    s_or_b32 s46, s46, s52
    s_xor_b32 s53, s53, s26
    s_or_b32 s46, s46, s53
    s_cmp_eq_u32 s46, 0
    s_cbranch_scc1 WAI2C
    s_add_u32 s54, s54, 1
    s_cmp_lt_u32 s54, 40000
    s_cbranch_scc1 POL2C
WAI2C:
    s_barrier
    s_barrier
    ds_read_b128 v[132:135], v180 offset:0
    ds_read_b64_tr_b16 v[148:149], v182 offset:0
    ds_read_b64_tr_b16 v[150:151], v182 offset:1024
    ds_read_b128 v[136:139], v180 offset:4096
    ds_read_b64_tr_b16 v[152:153], v183 offset:0
    ds_read_b64_tr_b16 v[154:155], v183 offset:1024
    ds_read_b64_tr_b16 v[156:157], v184 offset:0
    ds_read_b64_tr_b16 v[158:159], v184 offset:1024
    ds_read_b64_tr_b16 v[160:161], v185 offset:0
    ds_read_b64_tr_b16 v[162:163], v185 offset:1024
    s_waitcnt lgkmcnt(7)
    v_mfma_f32_32x32x16_bf16 v[4:19], v[148:151], v[132:135], v[4:19]
    ds_read_b128 v[140:143], v180 offset:1024
    ds_read_b64_tr_b16 v[164:165], v182 offset:4096
    s_waitcnt lgkmcnt(8)
    v_mfma_f32_32x32x16_bf16 v[20:35], v[148:151], v[136:139], v[20:35]
    ds_read_b64_tr_b16 v[166:167], v182 offset:5120
    s_waitcnt lgkmcnt(7)
    v_mfma_f32_32x32x16_bf16 v[36:51], v[152:155], v[132:135], v[36:51]
    ds_read_b128 v[144:147], v180 offset:5120
    v_mfma_f32_32x32x16_bf16 v[52:67], v[152:155], v[136:139], v[52:67]
    ds_read_b64_tr_b16 v[168:169], v183 offset:4096
    s_waitcnt lgkmcnt(7)
    v_mfma_f32_32x32x16_bf16 v[68:83], v[156:159], v[132:135], v[68:83]
    ds_read_b64_tr_b16 v[170:171], v183 offset:5120
    ds_read_b64_tr_b16 v[172:173], v184 offset:4096
    v_mfma_f32_32x32x16_bf16 v[84:99], v[156:159], v[136:139], v[84:99]
    ds_read_b64_tr_b16 v[174:175], v184 offset:5120
    s_waitcnt lgkmcnt(8)
    v_mfma_f32_32x32x16_bf16 v[100:115], v[160:163], v[132:135], v[100:115]
    ds_read_b64_tr_b16 v[176:177], v185 offset:4096
    v_mfma_f32_32x32x16_bf16 v[116:131], v[160:163], v[136:139], v[116:131]
    ds_read_b64_tr_b16 v[178:179], v185 offset:5120
    s_waitcnt lgkmcnt(7)
    v_mfma_f32_32x32x16_bf16 v[4:19], v[164:167], v[140:143], v[4:19]
    ds_read_b128 v[132:135], v180 offset:2048
    ds_read_b64_tr_b16 v[148:149], v182 offset:8192
    s_waitcnt lgkmcnt(8)
    v_mfma_f32_32x32x16_bf16 v[20:35], v[164:167], v[144:147], v[20:35]
    ds_read_b64_tr_b16 v[150:151], v182 offset:9216
    s_waitcnt lgkmcnt(7)
    v_mfma_f32_32x32x16_bf16 v[36:51], v[168:171], v[140:143], v[36:51]
    ds_read_b128 v[136:139], v180 offset:6144
    v_mfma_f32_32x32x16_bf16 v[52:67], v[168:171], v[144:147], v[52:67]
    ds_read_b64_tr_b16 v[152:153], v183 offset:8192
    s_waitcnt lgkmcnt(7)
    v_mfma_f32_32x32x16_bf16 v[68:83], v[172:175], v[140:143], v[68:83]
    ds_read_b64_tr_b16 v[154:155], v183 offset:9216
    ds_read_b64_tr_b16 v[156:157], v184 offset:8192
    v_mfma_f32_32x32x16_bf16 v[84:99], v[172:175], v[144:147], v[84:99]
    ds_read_b64_tr_b16 v[158:159], v184 offset:9216
    s_waitcnt lgkmcnt(8)
    v_mfma_f32_32x32x16_bf16 v[100:115], v[176:179], v[140:143], v[100:115]
    ds_read_b64_tr_b16 v[160:161], v185 offset:8192
    v_mfma_f32_32x32x16_bf16 v[116:131], v[176:179], v[144:147], v[116:131]
    ds_read_b64_tr_b16 v[162:163], v185 offset:9216
    s_waitcnt lgkmcnt(7)
    v_mfma_f32_32x32x16_bf16 v[4:19], v[148:151], v[132:135], v[4:19]
    ds_read_b128 v[140:143], v180 offset:3072
    ds_read_b64_tr_b16 v[164:165], v182 offset:12288
    s_waitcnt lgkmcnt(8)
    v_mfma_f32_32x32x16_bf16 v[20:35], v[148:151], v[136:139], v[20:35]
    ds_read_b64_tr_b16 v[166:167], v182 offset:13312
    s_waitcnt lgkmcnt(7)
    v_mfma_f32_32x32x16_bf16 v[36:51], v[152:155], v[132:135], v[36:51]
    ds_read_b128 v[144:147], v180 offset:7168
    v_mfma_f32_32x32x16_bf16 v[52:67], v[152:155], v[136:139], v[52:67]
    ds_read_b64_tr_b16 v[168:169], v183 offset:12288
    s_waitcnt lgkmcnt(7)
    v_mfma_f32_32x32x16_bf16 v[68:83], v[156:159], v[132:135], v[68:83]
    ds_read_b64_tr_b16 v[170:171], v183 offset:13312
    ds_read_b64_tr_b16 v[172:173], v184 offset:12288
    v_mfma_f32_32x32x16_bf16 v[84:99], v[156:159], v[136:139], v[84:99]
    ds_read_b64_tr_b16 v[174:175], v184 offset:13312
    s_waitcnt lgkmcnt(8)
    v_mfma_f32_32x32x16_bf16 v[100:115], v[160:163], v[132:135], v[100:115]
    ds_read_b64_tr_b16 v[176:177], v185 offset:12288
    v_mfma_f32_32x32x16_bf16 v[116:131], v[160:163], v[136:139], v[116:131]
    ds_read_b64_tr_b16 v[178:179], v185 offset:13312
    s_waitcnt lgkmcnt(7)
    v_mfma_f32_32x32x16_bf16 v[4:19], v[164:167], v[140:143], v[4:19]
    s_waitcnt lgkmcnt(6)
    v_mfma_f32_32x32x16_bf16 v[20:35], v[164:167], v[144:147], v[20:35]
    s_waitcnt lgkmcnt(4)
    v_mfma_f32_32x32x16_bf16 v[36:51], v[168:171], v[140:143], v[36:51]
    s_waitcnt lgkmcnt(0)
    s_barrier
    v_add_u32 v180, 0xc000, v180
    v_add_u32 v182, 0xc000, v182
    v_add_u32 v183, 0xc000, v183
    v_add_u32 v184, 0xc000, v184
    v_add_u32 v185, 0xc000, v185
    v_mfma_f32_32x32x16_bf16 v[52:67], v[168:171], v[144:147], v[52:67]
    ds_read_b128 v[132:135], v180 offset:0
    ds_read_b64_tr_b16 v[148:149], v182 offset:0
    v_mfma_f32_32x32x16_bf16 v[68:83], v[172:175], v[140:143], v[68:83]
    ds_read_b64_tr_b16 v[150:151], v182 offset:1024
    ds_read_b128 v[136:139], v180 offset:4096
    v_mfma_f32_32x32x16_bf16 v[84:99], v[172:175], v[144:147], v[84:99]
    ds_read_b64_tr_b16 v[152:153], v183 offset:0
    ds_read_b64_tr_b16 v[154:155], v183 offset:1024
    v_mfma_f32_32x32x16_bf16 v[100:115], v[176:179], v[140:143], v[100:115]
    ds_read_b64_tr_b16 v[156:157], v184 offset:0
    ds_read_b64_tr_b16 v[158:159], v184 offset:1024
    v_mfma_f32_32x32x16_bf16 v[116:131], v[176:179], v[144:147], v[116:131]
    ds_read_b64_tr_b16 v[160:161], v185 offset:0
    ds_read_b64_tr_b16 v[162:163], v185 offset:1024
    s_waitcnt lgkmcnt(7)
    v_mfma_f32_32x32x16_bf16 v[4:19], v[148:151], v[132:135], v[4:19]
    ds_read_b128 v[140:143], v180 offset:1024
    ds_read_b64_tr_b16 v[164:165], v182 offset:4096
    s_waitcnt lgkmcnt(8)
    v_mfma_f32_32x32x16_bf16 v[20:35], v[148:151], v[136:139], v[20:35]
    ds_read_b64_tr_b16 v[166:167], v182 offset:5120
    s_waitcnt lgkmcnt(7)
    v_mfma_f32_32x32x16_bf16 v[36:51], v[152:155], v[132:135], v[36:51]
    ds_read_b128 v[144:147], v180 offset:5120
    v_mfma_f32_32x32x16_bf16 v[52:67], v[152:155], v[136:139], v[52:67]
    ds_read_b64_tr_b16 v[168:169], v183 offset:4096
    s_waitcnt lgkmcnt(7)
    v_mfma_f32_32x32x16_bf16 v[68:83], v[156:159], v[132:135], v[68:83]
    ds_read_b64_tr_b16 v[170:171], v183 offset:5120
    ds_read_b64_tr_b16 v[172:173], v184 offset:4096
    v_mfma_f32_32x32x16_bf16 v[84:99], v[156:159], v[136:139], v[84:99]
    ds_read_b64_tr_b16 v[174:175], v184 offset:5120
    s_waitcnt lgkmcnt(8)
    v_mfma_f32_32x32x16_bf16 v[100:115], v[160:163], v[132:135], v[100:115]
    ds_read_b64_tr_b16 v[176:177], v185 offset:4096
    v_mfma_f32_32x32x16_bf16 v[116:131], v[160:163], v[136:139], v[116:131]
    ds_read_b64_tr_b16 v[178:179], v185 offset:5120
    s_waitcnt lgkmcnt(7)
    v_mfma_f32_32x32x16_bf16 v[4:19], v[164:167], v[140:143], v[4:19]
    ds_read_b128 v[132:135], v180 offset:2048
    ds_read_b64_tr_b16 v[148:149], v182 offset:8192
    s_waitcnt lgkmcnt(8)
    v_mfma_f32_32x32x16_bf16 v[20:35], v[164:167], v[144:147], v[20:35]
    ds_read_b64_tr_b16 v[150:151], v182 offset:9216
    s_waitcnt lgkmcnt(7)
    v_mfma_f32_32x32x16_bf16 v[36:51], v[168:171], v[140:143], v[36:51]
    ds_read_b128 v[136:139], v180 offset:6144
    v_mfma_f32_32x32x16_bf16 v[52:67], v[168:171], v[144:147], v[52:67]
    ds_read_b64_tr_b16 v[152:153], v183 offset:8192
    s_waitcnt lgkmcnt(7)
    v_mfma_f32_32x32x16_bf16 v[68:83], v[172:175], v[140:143], v[68:83]
    ds_read_b64_tr_b16 v[154:155], v183 offset:9216
    ds_read_b64_tr_b16 v[156:157], v184 offset:8192
    v_mfma_f32_32x32x16_bf16 v[84:99], v[172:175], v[144:147], v[84:99]
    ds_read_b64_tr_b16 v[158:159], v184 offset:9216
    s_waitcnt lgkmcnt(8)
    v_mfma_f32_32x32x16_bf16 v[100:115], v[176:179], v[140:143], v[100:115]
    ds_read_b64_tr_b16 v[160:161], v185 offset:8192
    v_mfma_f32_32x32x16_bf16 v[116:131], v[176:179], v[144:147], v[116:131]
    ds_read_b64_tr_b16 v[162:163], v185 offset:9216
    s_waitcnt lgkmcnt(7)
    v_mfma_f32_32x32x16_bf16 v[4:19], v[148:151], v[132:135], v[4:19]
    ds_read_b128 v[140:143], v180 offset:3072
    ds_read_b64_tr_b16 v[164:165], v182 offset:12288
    s_waitcnt lgkmcnt(8)
    v_mfma_f32_32x32x16_bf16 v[20:35], v[148:151], v[136:139], v[20:35]
    ds_read_b64_tr_b16 v[166:167], v182 offset:13312
    s_waitcnt lgkmcnt(7)
    v_mfma_f32_32x32x16_bf16 v[36:51], v[152:155], v[132:135], v[36:51]
    ds_read_b128 v[144:147], v180 offset:7168
    v_mfma_f32_32x32x16_bf16 v[52:67], v[152:155], v[136:139], v[52:67]
    ds_read_b64_tr_b16 v[168:169], v183 offset:12288
    s_waitcnt lgkmcnt(7)
    v_mfma_f32_32x32x16_bf16 v[68:83], v[156:159], v[132:135], v[68:83]
    ds_read_b64_tr_b16 v[170:171], v183 offset:13312
    ds_read_b64_tr_b16 v[172:173], v184 offset:12288
    v_mfma_f32_32x32x16_bf16 v[84:99], v[156:159], v[136:139], v[84:99]
    ds_read_b64_tr_b16 v[174:175], v184 offset:13312
    s_waitcnt lgkmcnt(8)
    v_mfma_f32_32x32x16_bf16 v[100:115], v[160:163], v[132:135], v[100:115]
    ds_read_b64_tr_b16 v[176:177], v185 offset:12288
    v_mfma_f32_32x32x16_bf16 v[116:131], v[160:163], v[136:139], v[116:131]
    ds_read_b64_tr_b16 v[178:179], v185 offset:13312
    s_waitcnt lgkmcnt(7)
    v_mfma_f32_32x32x16_bf16 v[4:19], v[164:167], v[140:143], v[4:19]
    s_waitcnt lgkmcnt(6)
    v_mfma_f32_32x32x16_bf16 v[20:35], v[164:167], v[144:147], v[20:35]
    s_waitcnt lgkmcnt(4)
    v_mfma_f32_32x32x16_bf16 v[36:51], v[168:171], v[140:143], v[36:51]
    s_waitcnt lgkmcnt(0)
    s_barrier
    v_add_u32 v180, 0xc000, v180
    v_add_u32 v182, 0xc000, v182
    v_add_u32 v183, 0xc000, v183
    v_add_u32 v184, 0xc000, v184
    v_add_u32 v185, 0xc000, v185
    v_mfma_f32_32x32x16_bf16 v[52:67], v[168:171], v[144:147], v[52:67]
    ds_read_b128 v[132:135], v180 offset:0
    ds_read_b64_tr_b16 v[148:149], v182 offset:0
    v_mfma_f32_32x32x16_bf16 v[68:83], v[172:175], v[140:143], v[68:83]
    ds_read_b64_tr_b16 v[150:151], v182 offset:1024
    ds_read_b128 v[136:139], v180 offset:4096
    v_mfma_f32_32x32x16_bf16 v[84:99], v[172:175], v[144:147], v[84:99]
    ds_read_b64_tr_b16 v[152:153], v183 offset:0
    ds_read_b64_tr_b16 v[154:155], v183 offset:1024
    v_mfma_f32_32x32x16_bf16 v[100:115], v[176:179], v[140:143], v[100:115]
    ds_read_b64_tr_b16 v[156:157], v184 offset:0
    ds_read_b64_tr_b16 v[158:159], v184 offset:1024
    v_mfma_f32_32x32x16_bf16 v[116:131], v[176:179], v[144:147], v[116:131]
    ds_read_b64_tr_b16 v[160:161], v185 offset:0
    ds_read_b64_tr_b16 v[162:163], v185 offset:1024
    s_waitcnt lgkmcnt(7)
    v_mfma_f32_32x32x16_bf16 v[4:19], v[148:151], v[132:135], v[4:19]
    ds_read_b128 v[140:143], v180 offset:1024
    ds_read_b64_tr_b16 v[164:165], v182 offset:4096
    s_waitcnt lgkmcnt(8)
    v_mfma_f32_32x32x16_bf16 v[20:35], v[148:151], v[136:139], v[20:35]
    ds_read_b64_tr_b16 v[166:167], v182 offset:5120
    s_waitcnt lgkmcnt(7)
    v_mfma_f32_32x32x16_bf16 v[36:51], v[152:155], v[132:135], v[36:51]
    ds_read_b128 v[144:147], v180 offset:5120
    v_mfma_f32_32x32x16_bf16 v[52:67], v[152:155], v[136:139], v[52:67]
    ds_read_b64_tr_b16 v[168:169], v183 offset:4096
    s_waitcnt lgkmcnt(7)
    v_mfma_f32_32x32x16_bf16 v[68:83], v[156:159], v[132:135], v[68:83]
    ds_read_b64_tr_b16 v[170:171], v183 offset:5120
    ds_read_b64_tr_b16 v[172:173], v184 offset:4096
    v_mfma_f32_32x32x16_bf16 v[84:99], v[156:159], v[136:139], v[84:99]
    ds_read_b64_tr_b16 v[174:175], v184 offset:5120
    s_waitcnt lgkmcnt(8)
    v_mfma_f32_32x32x16_bf16 v[100:115], v[160:163], v[132:135], v[100:115]
    ds_read_b64_tr_b16 v[176:177], v185 offset:4096
    v_mfma_f32_32x32x16_bf16 v[116:131], v[160:163], v[136:139], v[116:131]
    ds_read_b64_tr_b16 v[178:179], v185 offset:5120
    s_waitcnt lgkmcnt(7)
    v_mfma_f32_32x32x16_bf16 v[4:19], v[164:167], v[140:143], v[4:19]
    ds_read_b128 v[132:135], v180 offset:2048
    ds_read_b64_tr_b16 v[148:149], v182 offset:8192
    s_waitcnt lgkmcnt(8)
    v_mfma_f32_32x32x16_bf16 v[20:35], v[164:167], v[144:147], v[20:35]
    ds_read_b64_tr_b16 v[150:151], v182 offset:9216
    s_waitcnt lgkmcnt(7)
    v_mfma_f32_32x32x16_bf16 v[36:51], v[168:171], v[140:143], v[36:51]
    ds_read_b128 v[136:139], v180 offset:6144
    v_mfma_f32_32x32x16_bf16 v[52:67], v[168:171], v[144:147], v[52:67]
    ds_read_b64_tr_b16 v[152:153], v183 offset:8192
    s_waitcnt lgkmcnt(7)
    v_mfma_f32_32x32x16_bf16 v[68:83], v[172:175], v[140:143], v[68:83]
    ds_read_b64_tr_b16 v[154:155], v183 offset:9216
    ds_read_b64_tr_b16 v[156:157], v184 offset:8192
    v_mfma_f32_32x32x16_bf16 v[84:99], v[172:175], v[144:147], v[84:99]
    ds_read_b64_tr_b16 v[158:159], v184 offset:9216
    s_waitcnt lgkmcnt(8)
    v_mfma_f32_32x32x16_bf16 v[100:115], v[176:179], v[140:143], v[100:115]
    ds_read_b64_tr_b16 v[160:161], v185 offset:8192
    v_mfma_f32_32x32x16_bf16 v[116:131], v[176:179], v[144:147], v[116:131]
    ds_read_b64_tr_b16 v[162:163], v185 offset:9216
    s_waitcnt lgkmcnt(7)
    v_mfma_f32_32x32x16_bf16 v[4:19], v[148:151], v[132:135], v[4:19]
    ds_read_b128 v[140:143], v180 offset:3072
    ds_read_b64_tr_b16 v[164:165], v182 offset:12288
    s_waitcnt lgkmcnt(8)
    v_mfma_f32_32x32x16_bf16 v[20:35], v[148:151], v[136:139], v[20:35]
    ds_read_b64_tr_b16 v[166:167], v182 offset:13312
    s_waitcnt lgkmcnt(7)
    v_mfma_f32_32x32x16_bf16 v[36:51], v[152:155], v[132:135], v[36:51]
    ds_read_b128 v[144:147], v180 offset:7168
    v_mfma_f32_32x32x16_bf16 v[52:67], v[152:155], v[136:139], v[52:67]
    ds_read_b64_tr_b16 v[168:169], v183 offset:12288
    s_waitcnt lgkmcnt(7)
    v_mfma_f32_32x32x16_bf16 v[68:83], v[156:159], v[132:135], v[68:83]
    ds_read_b64_tr_b16 v[170:171], v183 offset:13312
    ds_read_b64_tr_b16 v[172:173], v184 offset:12288
    v_mfma_f32_32x32x16_bf16 v[84:99], v[156:159], v[136:139], v[84:99]
    ds_read_b64_tr_b16 v[174:175], v184 offset:13312
    s_waitcnt lgkmcnt(8)
    v_mfma_f32_32x32x16_bf16 v[100:115], v[160:163], v[132:135], v[100:115]
    ds_read_b64_tr_b16 v[176:177], v185 offset:12288
    v_mfma_f32_32x32x16_bf16 v[116:131], v[160:163], v[136:139], v[116:131]
    ds_read_b64_tr_b16 v[178:179], v185 offset:13312
    s_waitcnt lgkmcnt(7)
    v_mfma_f32_32x32x16_bf16 v[4:19], v[164:167], v[140:143], v[4:19]
    s_waitcnt lgkmcnt(6)
    v_mfma_f32_32x32x16_bf16 v[20:35], v[164:167], v[144:147], v[20:35]
    s_waitcnt lgkmcnt(4)
    v_mfma_f32_32x32x16_bf16 v[36:51], v[168:171], v[140:143], v[36:51]
    s_waitcnt lgkmcnt(0)
    s_barrier
    v_add_u32 v180, 0xfffe8000, v180
    v_add_u32 v182, 0xfffe8000, v182
    v_add_u32 v183, 0xfffe8000, v183
    v_add_u32 v184, 0xfffe8000, v184
    v_add_u32 v185, 0xfffe8000, v185
    v_mfma_f32_32x32x16_bf16 v[52:67], v[168:171], v[144:147], v[52:67]
    ds_read_b128 v[132:135], v180 offset:0
    ds_read_b64_tr_b16 v[148:149], v182 offset:0
    v_mfma_f32_32x32x16_bf16 v[68:83], v[172:175], v[140:143], v[68:83]
    ds_read_b64_tr_b16 v[150:151], v182 offset:1024
    ds_read_b128 v[136:139], v180 offset:4096
    v_mfma_f32_32x32x16_bf16 v[84:99], v[172:175], v[144:147], v[84:99]
    ds_read_b64_tr_b16 v[152:153], v183 offset:0
    ds_read_b64_tr_b16 v[154:155], v183 offset:1024
    v_mfma_f32_32x32x16_bf16 v[100:115], v[176:179], v[140:143], v[100:115]
    ds_read_b64_tr_b16 v[156:157], v184 offset:0
    ds_read_b64_tr_b16 v[158:159], v184 offset:1024
    v_mfma_f32_32x32x16_bf16 v[116:131], v[176:179], v[144:147], v[116:131]
    ds_read_b64_tr_b16 v[160:161], v185 offset:0
    ds_read_b64_tr_b16 v[162:163], v185 offset:1024
    s_waitcnt lgkmcnt(7)
    v_mfma_f32_32x32x16_bf16 v[4:19], v[148:151], v[132:135], v[4:19]
    ds_read_b128 v[140:143], v180 offset:1024
    ds_read_b64_tr_b16 v[164:165], v182 offset:4096
    s_waitcnt lgkmcnt(8)
    v_mfma_f32_32x32x16_bf16 v[20:35], v[148:151], v[136:139], v[20:35]
    ds_read_b64_tr_b16 v[166:167], v182 offset:5120
    s_waitcnt lgkmcnt(7)
    v_mfma_f32_32x32x16_bf16 v[36:51], v[152:155], v[132:135], v[36:51]
    ds_read_b128 v[144:147], v180 offset:5120
    v_mfma_f32_32x32x16_bf16 v[52:67], v[152:155], v[136:139], v[52:67]
    ds_read_b64_tr_b16 v[168:169], v183 offset:4096
    s_waitcnt lgkmcnt(7)
    v_mfma_f32_32x32x16_bf16 v[68:83], v[156:159], v[132:135], v[68:83]
    ds_read_b64_tr_b16 v[170:171], v183 offset:5120
    ds_read_b64_tr_b16 v[172:173], v184 offset:4096
    v_mfma_f32_32x32x16_bf16 v[84:99], v[156:159], v[136:139], v[84:99]
    ds_read_b64_tr_b16 v[174:175], v184 offset:5120
    s_waitcnt lgkmcnt(8)
    v_mfma_f32_32x32x16_bf16 v[100:115], v[160:163], v[132:135], v[100:115]
    ds_read_b64_tr_b16 v[176:177], v185 offset:4096
    v_mfma_f32_32x32x16_bf16 v[116:131], v[160:163], v[136:139], v[116:131]
    ds_read_b64_tr_b16 v[178:179], v185 offset:5120
    s_waitcnt lgkmcnt(7)
    v_mfma_f32_32x32x16_bf16 v[4:19], v[164:167], v[140:143], v[4:19]
    ds_read_b128 v[132:135], v180 offset:2048
    ds_read_b64_tr_b16 v[148:149], v182 offset:8192
    s_waitcnt lgkmcnt(8)
    v_mfma_f32_32x32x16_bf16 v[20:35], v[164:167], v[144:147], v[20:35]
    ds_read_b64_tr_b16 v[150:151], v182 offset:9216
    s_waitcnt lgkmcnt(7)
    v_mfma_f32_32x32x16_bf16 v[36:51], v[168:171], v[140:143], v[36:51]
    ds_read_b128 v[136:139], v180 offset:6144
    v_mfma_f32_32x32x16_bf16 v[52:67], v[168:171], v[144:147], v[52:67]
    ds_read_b64_tr_b16 v[152:153], v183 offset:8192
    s_waitcnt lgkmcnt(7)
    v_mfma_f32_32x32x16_bf16 v[68:83], v[172:175], v[140:143], v[68:83]
    ds_read_b64_tr_b16 v[154:155], v183 offset:9216
    ds_read_b64_tr_b16 v[156:157], v184 offset:8192
    v_mfma_f32_32x32x16_bf16 v[84:99], v[172:175], v[144:147], v[84:99]
    ds_read_b64_tr_b16 v[158:159], v184 offset:9216
    s_waitcnt lgkmcnt(8)
    v_mfma_f32_32x32x16_bf16 v[100:115], v[176:179], v[140:143], v[100:115]
    ds_read_b64_tr_b16 v[160:161], v185 offset:8192
    v_mfma_f32_32x32x16_bf16 v[116:131], v[176:179], v[144:147], v[116:131]
    ds_read_b64_tr_b16 v[162:163], v185 offset:9216
    s_waitcnt lgkmcnt(7)
    v_mfma_f32_32x32x16_bf16 v[4:19], v[148:151], v[132:135], v[4:19]
    ds_read_b128 v[140:143], v180 offset:3072
    ds_read_b64_tr_b16 v[164:165], v182 offset:12288
    s_waitcnt lgkmcnt(8)
    v_mfma_f32_32x32x16_bf16 v[20:35], v[148:151], v[136:139], v[20:35]
    ds_read_b64_tr_b16 v[166:167], v182 offset:13312
    s_waitcnt lgkmcnt(7)
    v_mfma_f32_32x32x16_bf16 v[36:51], v[152:155], v[132:135], v[36:51]
    ds_read_b128 v[144:147], v180 offset:7168
    v_mfma_f32_32x32x16_bf16 v[52:67], v[152:155], v[136:139], v[52:67]
    ds_read_b64_tr_b16 v[168:169], v183 offset:12288
    s_waitcnt lgkmcnt(7)
    v_mfma_f32_32x32x16_bf16 v[68:83], v[156:159], v[132:135], v[68:83]
    ds_read_b64_tr_b16 v[170:171], v183 offset:13312
    ds_read_b64_tr_b16 v[172:173], v184 offset:12288
    v_mfma_f32_32x32x16_bf16 v[84:99], v[156:159], v[136:139], v[84:99]
    ds_read_b64_tr_b16 v[174:175], v184 offset:13312
    s_waitcnt lgkmcnt(8)
    v_mfma_f32_32x32x16_bf16 v[100:115], v[160:163], v[132:135], v[100:115]
    ds_read_b64_tr_b16 v[176:177], v185 offset:12288
    v_mfma_f32_32x32x16_bf16 v[116:131], v[160:163], v[136:139], v[116:131]
    ds_read_b64_tr_b16 v[178:179], v185 offset:13312
    s_waitcnt lgkmcnt(7)
    v_mfma_f32_32x32x16_bf16 v[4:19], v[164:167], v[140:143], v[4:19]
    s_waitcnt lgkmcnt(6)
    v_mfma_f32_32x32x16_bf16 v[20:35], v[164:167], v[144:147], v[20:35]
    s_waitcnt lgkmcnt(4)
    v_mfma_f32_32x32x16_bf16 v[36:51], v[168:171], v[140:143], v[36:51]
    s_waitcnt lgkmcnt(0)
    s_barrier
    v_add_u32 v180, 0xc000, v180
    v_add_u32 v182, 0xc000, v182
    v_add_u32 v183, 0xc000, v183
    v_add_u32 v184, 0xc000, v184
    v_add_u32 v185, 0xc000, v185
    v_mfma_f32_32x32x16_bf16 v[52:67], v[168:171], v[144:147], v[52:67]
    ds_read_b128 v[132:135], v180 offset:0
    ds_read_b64_tr_b16 v[148:149], v182 offset:0
    v_mfma_f32_32x32x16_bf16 v[68:83], v[172:175], v[140:143], v[68:83]
    ds_read_b64_tr_b16 v[150:151], v182 offset:1024
    ds_read_b128 v[136:139], v180 offset:4096
    v_mfma_f32_32x32x16_bf16 v[84:99], v[172:175], v[144:147], v[84:99]
    ds_read_b64_tr_b16 v[152:153], v183 offset:0
    ds_read_b64_tr_b16 v[154:155], v183 offset:1024
    v_mfma_f32_32x32x16_bf16 v[100:115], v[176:179], v[140:143], v[100:115]
    ds_read_b64_tr_b16 v[156:157], v184 offset:0
    ds_read_b64_tr_b16 v[158:159], v184 offset:1024
    v_mfma_f32_32x32x16_bf16 v[116:131], v[176:179], v[144:147], v[116:131]
    ds_read_b64_tr_b16 v[160:161], v185 offset:0
    ds_read_b64_tr_b16 v[162:163], v185 offset:1024
    s_waitcnt lgkmcnt(7)
    v_mfma_f32_32x32x16_bf16 v[4:19], v[148:151], v[132:135], v[4:19]
    ds_read_b128 v[140:143], v180 offset:1024
    ds_read_b64_tr_b16 v[164:165], v182 offset:4096
    s_waitcnt lgkmcnt(8)
    v_mfma_f32_32x32x16_bf16 v[20:35], v[148:151], v[136:139], v[20:35]
    ds_read_b64_tr_b16 v[166:167], v182 offset:5120
    s_waitcnt lgkmcnt(7)
    v_mfma_f32_32x32x16_bf16 v[36:51], v[152:155], v[132:135], v[36:51]
    ds_read_b128 v[144:147], v180 offset:5120
    v_mfma_f32_32x32x16_bf16 v[52:67], v[152:155], v[136:139], v[52:67]
    ds_read_b64_tr_b16 v[168:169], v183 offset:4096
    s_waitcnt lgkmcnt(7)
    v_mfma_f32_32x32x16_bf16 v[68:83], v[156:159], v[132:135], v[68:83]
    ds_read_b64_tr_b16 v[170:171], v183 offset:5120
    ds_read_b64_tr_b16 v[172:173], v184 offset:4096
    v_mfma_f32_32x32x16_bf16 v[84:99], v[156:159], v[136:139], v[84:99]
    ds_read_b64_tr_b16 v[174:175], v184 offset:5120
    s_waitcnt lgkmcnt(8)
    v_mfma_f32_32x32x16_bf16 v[100:115], v[160:163], v[132:135], v[100:115]
    ds_read_b64_tr_b16 v[176:177], v185 offset:4096
    v_mfma_f32_32x32x16_bf16 v[116:131], v[160:163], v[136:139], v[116:131]
    ds_read_b64_tr_b16 v[178:179], v185 offset:5120
    s_waitcnt lgkmcnt(7)
    v_mfma_f32_32x32x16_bf16 v[4:19], v[164:167], v[140:143], v[4:19]
    ds_read_b128 v[132:135], v180 offset:2048
    ds_read_b64_tr_b16 v[148:149], v182 offset:8192
    s_waitcnt lgkmcnt(8)
    v_mfma_f32_32x32x16_bf16 v[20:35], v[164:167], v[144:147], v[20:35]
    ds_read_b64_tr_b16 v[150:151], v182 offset:9216
    s_waitcnt lgkmcnt(7)
    v_mfma_f32_32x32x16_bf16 v[36:51], v[168:171], v[140:143], v[36:51]
    ds_read_b128 v[136:139], v180 offset:6144
    v_mfma_f32_32x32x16_bf16 v[52:67], v[168:171], v[144:147], v[52:67]
    ds_read_b64_tr_b16 v[152:153], v183 offset:8192
    s_waitcnt lgkmcnt(7)
    v_mfma_f32_32x32x16_bf16 v[68:83], v[172:175], v[140:143], v[68:83]
    ds_read_b64_tr_b16 v[154:155], v183 offset:9216
    ds_read_b64_tr_b16 v[156:157], v184 offset:8192
    v_mfma_f32_32x32x16_bf16 v[84:99], v[172:175], v[144:147], v[84:99]
    ds_read_b64_tr_b16 v[158:159], v184 offset:9216
    s_waitcnt lgkmcnt(8)
    v_mfma_f32_32x32x16_bf16 v[100:115], v[176:179], v[140:143], v[100:115]
    ds_read_b64_tr_b16 v[160:161], v185 offset:8192
    v_mfma_f32_32x32x16_bf16 v[116:131], v[176:179], v[144:147], v[116:131]
    ds_read_b64_tr_b16 v[162:163], v185 offset:9216
    s_waitcnt lgkmcnt(7)
    v_mfma_f32_32x32x16_bf16 v[4:19], v[148:151], v[132:135], v[4:19]
    ds_read_b128 v[140:143], v180 offset:3072
    ds_read_b64_tr_b16 v[164:165], v182 offset:12288
    s_waitcnt lgkmcnt(8)
    v_mfma_f32_32x32x16_bf16 v[20:35], v[148:151], v[136:139], v[20:35]
    ds_read_b64_tr_b16 v[166:167], v182 offset:13312
    s_waitcnt lgkmcnt(7)
    v_mfma_f32_32x32x16_bf16 v[36:51], v[152:155], v[132:135], v[36:51]
    ds_read_b128 v[144:147], v180 offset:7168
    v_mfma_f32_32x32x16_bf16 v[52:67], v[152:155], v[136:139], v[52:67]
    ds_read_b64_tr_b16 v[168:169], v183 offset:12288
    s_waitcnt lgkmcnt(7)
    v_mfma_f32_32x32x16_bf16 v[68:83], v[156:159], v[132:135], v[68:83]
    ds_read_b64_tr_b16 v[170:171], v183 offset:13312
    ds_read_b64_tr_b16 v[172:173], v184 offset:12288
    v_mfma_f32_32x32x16_bf16 v[84:99], v[156:159], v[136:139], v[84:99]
    ds_read_b64_tr_b16 v[174:175], v184 offset:13312
    s_waitcnt lgkmcnt(8)
    v_mfma_f32_32x32x16_bf16 v[100:115], v[160:163], v[132:135], v[100:115]
    ds_read_b64_tr_b16 v[176:177], v185 offset:12288
    v_mfma_f32_32x32x16_bf16 v[116:131], v[160:163], v[136:139], v[116:131]
    ds_read_b64_tr_b16 v[178:179], v185 offset:13312
    s_waitcnt lgkmcnt(7)
    v_mfma_f32_32x32x16_bf16 v[4:19], v[164:167], v[140:143], v[4:19]
    s_waitcnt lgkmcnt(6)
    v_mfma_f32_32x32x16_bf16 v[20:35], v[164:167], v[144:147], v[20:35]
    s_waitcnt lgkmcnt(4)
    v_mfma_f32_32x32x16_bf16 v[36:51], v[168:171], v[140:143], v[36:51]
    s_waitcnt lgkmcnt(0)
    s_barrier
    v_add_u32 v180, 0xc000, v180
    v_add_u32 v182, 0xc000, v182
    v_add_u32 v183, 0xc000, v183
    v_add_u32 v184, 0xc000, v184
    v_add_u32 v185, 0xc000, v185
    v_mfma_f32_32x32x16_bf16 v[52:67], v[168:171], v[144:147], v[52:67]
    ds_read_b128 v[132:135], v180 offset:0
    ds_read_b64_tr_b16 v[148:149], v182 offset:0
    v_mfma_f32_32x32x16_bf16 v[68:83], v[172:175], v[140:143], v[68:83]
    ds_read_b64_tr_b16 v[150:151], v182 offset:1024
    ds_read_b128 v[136:139], v180 offset:4096
    v_mfma_f32_32x32x16_bf16 v[84:99], v[172:175], v[144:147], v[84:99]
    ds_read_b64_tr_b16 v[152:153], v183 offset:0
    ds_read_b64_tr_b16 v[154:155], v183 offset:1024
    v_mfma_f32_32x32x16_bf16 v[100:115], v[176:179], v[140:143], v[100:115]
    ds_read_b64_tr_b16 v[156:157], v184 offset:0
    ds_read_b64_tr_b16 v[158:159], v184 offset:1024
    v_mfma_f32_32x32x16_bf16 v[116:131], v[176:179], v[144:147], v[116:131]
    ds_read_b64_tr_b16 v[160:161], v185 offset:0
    ds_read_b64_tr_b16 v[162:163], v185 offset:1024
    s_waitcnt lgkmcnt(7)
    v_mfma_f32_32x32x16_bf16 v[4:19], v[148:151], v[132:135], v[4:19]
    ds_read_b128 v[140:143], v180 offset:1024
    ds_read_b64_tr_b16 v[164:165], v182 offset:4096
    s_waitcnt lgkmcnt(8)
    v_mfma_f32_32x32x16_bf16 v[20:35], v[148:151], v[136:139], v[20:35]
    ds_read_b64_tr_b16 v[166:167], v182 offset:5120
    s_waitcnt lgkmcnt(7)
    v_mfma_f32_32x32x16_bf16 v[36:51], v[152:155], v[132:135], v[36:51]
    ds_read_b128 v[144:147], v180 offset:5120
    v_mfma_f32_32x32x16_bf16 v[52:67], v[152:155], v[136:139], v[52:67]
    ds_read_b64_tr_b16 v[168:169], v183 offset:4096
    s_waitcnt lgkmcnt(7)
    v_mfma_f32_32x32x16_bf16 v[68:83], v[156:159], v[132:135], v[68:83]
    ds_read_b64_tr_b16 v[170:171], v183 offset:5120
    ds_read_b64_tr_b16 v[172:173], v184 offset:4096
    v_mfma_f32_32x32x16_bf16 v[84:99], v[156:159], v[136:139], v[84:99]
    ds_read_b64_tr_b16 v[174:175], v184 offset:5120
    s_waitcnt lgkmcnt(8)
    v_mfma_f32_32x32x16_bf16 v[100:115], v[160:163], v[132:135], v[100:115]
    ds_read_b64_tr_b16 v[176:177], v185 offset:4096
    v_mfma_f32_32x32x16_bf16 v[116:131], v[160:163], v[136:139], v[116:131]
    ds_read_b64_tr_b16 v[178:179], v185 offset:5120
    s_waitcnt lgkmcnt(7)
    v_mfma_f32_32x32x16_bf16 v[4:19], v[164:167], v[140:143], v[4:19]
    ds_read_b128 v[132:135], v180 offset:2048
    ds_read_b64_tr_b16 v[148:149], v182 offset:8192
    s_waitcnt lgkmcnt(8)
    v_mfma_f32_32x32x16_bf16 v[20:35], v[164:167], v[144:147], v[20:35]
    ds_read_b64_tr_b16 v[150:151], v182 offset:9216
    s_waitcnt lgkmcnt(7)
    v_mfma_f32_32x32x16_bf16 v[36:51], v[168:171], v[140:143], v[36:51]
    ds_read_b128 v[136:139], v180 offset:6144
    v_mfma_f32_32x32x16_bf16 v[52:67], v[168:171], v[144:147], v[52:67]
    ds_read_b64_tr_b16 v[152:153], v183 offset:8192
    s_waitcnt lgkmcnt(7)
    v_mfma_f32_32x32x16_bf16 v[68:83], v[172:175], v[140:143], v[68:83]
    ds_read_b64_tr_b16 v[154:155], v183 offset:9216
    ds_read_b64_tr_b16 v[156:157], v184 offset:8192
    v_mfma_f32_32x32x16_bf16 v[84:99], v[172:175], v[144:147], v[84:99]
    ds_read_b64_tr_b16 v[158:159], v184 offset:9216
    s_waitcnt lgkmcnt(8)
    v_mfma_f32_32x32x16_bf16 v[100:115], v[176:179], v[140:143], v[100:115]
    ds_read_b64_tr_b16 v[160:161], v185 offset:8192
    v_mfma_f32_32x32x16_bf16 v[116:131], v[176:179], v[144:147], v[116:131]
    ds_read_b64_tr_b16 v[162:163], v185 offset:9216
    s_waitcnt lgkmcnt(7)
    v_mfma_f32_32x32x16_bf16 v[4:19], v[148:151], v[132:135], v[4:19]
    ds_read_b128 v[140:143], v180 offset:3072
    ds_read_b64_tr_b16 v[164:165], v182 offset:12288
    s_waitcnt lgkmcnt(8)
    v_mfma_f32_32x32x16_bf16 v[20:35], v[148:151], v[136:139], v[20:35]
    ds_read_b64_tr_b16 v[166:167], v182 offset:13312
    s_waitcnt lgkmcnt(7)
    v_mfma_f32_32x32x16_bf16 v[36:51], v[152:155], v[132:135], v[36:51]
    ds_read_b128 v[144:147], v180 offset:7168
    v_mfma_f32_32x32x16_bf16 v[52:67], v[152:155], v[136:139], v[52:67]
    ds_read_b64_tr_b16 v[168:169], v183 offset:12288
    s_waitcnt lgkmcnt(7)
    v_mfma_f32_32x32x16_bf16 v[68:83], v[156:159], v[132:135], v[68:83]
    ds_read_b64_tr_b16 v[170:171], v183 offset:13312
    ds_read_b64_tr_b16 v[172:173], v184 offset:12288
    v_mfma_f32_32x32x16_bf16 v[84:99], v[156:159], v[136:139], v[84:99]
    ds_read_b64_tr_b16 v[174:175], v184 offset:13312
    s_waitcnt lgkmcnt(8)
    v_mfma_f32_32x32x16_bf16 v[100:115], v[160:163], v[132:135], v[100:115]
    ds_read_b64_tr_b16 v[176:177], v185 offset:12288
    v_mfma_f32_32x32x16_bf16 v[116:131], v[160:163], v[136:139], v[116:131]
    ds_read_b64_tr_b16 v[178:179], v185 offset:13312
    s_waitcnt lgkmcnt(7)
    v_mfma_f32_32x32x16_bf16 v[4:19], v[164:167], v[140:143], v[4:19]
    s_waitcnt lgkmcnt(6)
    v_mfma_f32_32x32x16_bf16 v[20:35], v[164:167], v[144:147], v[20:35]
    s_waitcnt lgkmcnt(4)
    v_mfma_f32_32x32x16_bf16 v[36:51], v[168:171], v[140:143], v[36:51]
    s_waitcnt lgkmcnt(0)
    s_barrier
    v_add_u32 v180, 0xfffe8000, v180
    v_add_u32 v182, 0xfffe8000, v182
    v_add_u32 v183, 0xfffe8000, v183
    v_add_u32 v184, 0xfffe8000, v184
    v_add_u32 v185, 0xfffe8000, v185
    v_mfma_f32_32x32x16_bf16 v[52:67], v[168:171], v[144:147], v[52:67]
    ds_read_b128 v[132:135], v180 offset:0
    ds_read_b64_tr_b16 v[148:149], v182 offset:0
    v_mfma_f32_32x32x16_bf16 v[68:83], v[172:175], v[140:143], v[68:83]
    ds_read_b64_tr_b16 v[150:151], v182 offset:1024
    ds_read_b128 v[136:139], v180 offset:4096
    v_mfma_f32_32x32x16_bf16 v[84:99], v[172:175], v[144:147], v[84:99]
    ds_read_b64_tr_b16 v[152:153], v183 offset:0
    ds_read_b64_tr_b16 v[154:155], v183 offset:1024
    v_mfma_f32_32x32x16_bf16 v[100:115], v[176:179], v[140:143], v[100:115]
    ds_read_b64_tr_b16 v[156:157], v184 offset:0
    ds_read_b64_tr_b16 v[158:159], v184 offset:1024
    v_mfma_f32_32x32x16_bf16 v[116:131], v[176:179], v[144:147], v[116:131]
    ds_read_b64_tr_b16 v[160:161], v185 offset:0
    ds_read_b64_tr_b16 v[162:163], v185 offset:1024
    s_waitcnt lgkmcnt(7)
    v_mfma_f32_32x32x16_bf16 v[4:19], v[148:151], v[132:135], v[4:19]
    ds_read_b128 v[140:143], v180 offset:1024
    ds_read_b64_tr_b16 v[164:165], v182 offset:4096
    v_bfe_u32 v188, v0, 3, 1
    v_lshlrev_b32 v188, 7, v188
    s_waitcnt lgkmcnt(8)
    v_mfma_f32_32x32x16_bf16 v[20:35], v[148:151], v[136:139], v[20:35]
    ds_read_b64_tr_b16 v[166:167], v182 offset:5120
    v_bfe_u32 v189, v0, 2, 1
    v_lshl_add_u32 v188, v189, 3, v188
    s_waitcnt lgkmcnt(7)
    v_mfma_f32_32x32x16_bf16 v[36:51], v[152:155], v[132:135], v[36:51]
    ds_read_b128 v[144:147], v180 offset:5120
    v_bfe_u32 v189, v0, 4, 1
    v_lshl_add_u32 v188, v189, 2, v188
    v_mfma_f32_32x32x16_bf16 v[52:67], v[152:155], v[136:139], v[52:67]
    ds_read_b64_tr_b16 v[168:169], v183 offset:4096
    v_and_b32 v189, 3, v0
    v_add_u32 v188, v188, v189
    s_waitcnt lgkmcnt(7)
    v_mfma_f32_32x32x16_bf16 v[68:83], v[156:159], v[132:135], v[68:83]
    ds_read_b64_tr_b16 v[170:171], v183 offset:5120
    ds_read_b64_tr_b16 v[172:173], v184 offset:4096
    v_lshlrev_b32 v188, 2, v188
    s_lshl_b32 s44, s60, 2
    v_mfma_f32_32x32x16_bf16 v[84:99], v[156:159], v[136:139], v[84:99]
    ds_read_b64_tr_b16 v[174:175], v184 offset:5120
    s_add_u32 s45, s44, 0
    s_lshl_b32 s45, s45, 6
    s_waitcnt lgkmcnt(8)
    v_mfma_f32_32x32x16_bf16 v[100:115], v[160:163], v[132:135], v[100:115]
    ds_read_b64_tr_b16 v[176:177], v185 offset:4096
    v_add_u32 v189, s45, v188
    ds_read_b32 v232, v189 offset:1024
    v_mfma_f32_32x32x16_bf16 v[116:131], v[160:163], v[136:139], v[116:131]
    ds_read_b64_tr_b16 v[178:179], v185 offset:5120
    ds_read_b32 v233, v189 offset:2048
    ds_read_b32 v234, v189 offset:3072
    s_waitcnt lgkmcnt(10)
    v_mfma_f32_32x32x16_bf16 v[4:19], v[164:167], v[140:143], v[4:19]
    ds_read_b128 v[132:135], v180 offset:2048
    ds_read_b64_tr_b16 v[148:149], v182 offset:8192
    ds_read_b32 v235, v189 offset:4096
    s_add_u32 s45, s44, 1
    s_waitcnt lgkmcnt(12)
    v_mfma_f32_32x32x16_bf16 v[20:35], v[164:167], v[144:147], v[20:35]
    ds_read_b64_tr_b16 v[150:151], v182 offset:9216
    s_lshl_b32 s45, s45, 6
    v_add_u32 v189, s45, v188
    s_waitcnt lgkmcnt(11)
    v_mfma_f32_32x32x16_bf16 v[36:51], v[168:171], v[140:143], v[36:51]
    ds_read_b128 v[136:139], v180 offset:6144
    ds_read_b32 v236, v189 offset:1024
    ds_read_b32 v237, v189 offset:2048
    v_mfma_f32_32x32x16_bf16 v[52:67], v[168:171], v[144:147], v[52:67]
    ds_read_b64_tr_b16 v[152:153], v183 offset:8192
    ds_read_b32 v238, v189 offset:3072
    ds_read_b32 v239, v189 offset:4096
    s_waitcnt lgkmcnt(15)
    v_mfma_f32_32x32x16_bf16 v[68:83], v[172:175], v[140:143], v[68:83]
    ds_read_b64_tr_b16 v[154:155], v183 offset:9216
    ds_read_b64_tr_b16 v[156:157], v184 offset:8192
    s_add_u32 s45, s44, 2
    s_lshl_b32 s45, s45, 6
    v_mfma_f32_32x32x16_bf16 v[84:99], v[172:175], v[144:147], v[84:99]
    ds_read_b64_tr_b16 v[158:159], v184 offset:9216
    v_add_u32 v189, s45, v188
    ds_read_b32 v240, v189 offset:1024
    s_waitcnt lgkmcnt(15)
    v_mfma_f32_32x32x16_bf16 v[100:115], v[176:179], v[140:143], v[100:115]
    ds_read_b64_tr_b16 v[160:161], v185 offset:8192
    ds_read_b32 v241, v189 offset:2048
    ds_read_b32 v242, v189 offset:3072
    v_mfma_f32_32x32x16_bf16 v[116:131], v[176:179], v[144:147], v[116:131]
    ds_read_b64_tr_b16 v[162:163], v185 offset:9216
    ds_read_b32 v243, v189 offset:4096
    s_add_u32 s45, s44, 3
    s_waitcnt lgkmcnt(15)
    v_mfma_f32_32x32x16_bf16 v[4:19], v[148:151], v[132:135], v[4:19]
    ds_read_b128 v[140:143], v180 offset:3072
    ds_read_b64_tr_b16 v[164:165], v182 offset:12288
    s_lshl_b32 s45, s45, 6
    v_add_u32 v189, s45, v188
    s_waitcnt lgkmcnt(15)
    v_mfma_f32_32x32x16_bf16 v[20:35], v[148:151], v[136:139], v[20:35]
    ds_read_b64_tr_b16 v[166:167], v182 offset:13312
    ds_read_b32 v244, v189 offset:1024
    ds_read_b32 v245, v189 offset:2048
    s_waitcnt lgkmcnt(13)
    v_mfma_f32_32x32x16_bf16 v[36:51], v[152:155], v[132:135], v[36:51]
    ds_read_b128 v[144:147], v180 offset:7168
    ds_read_b32 v246, v189 offset:3072
    ds_read_b32 v247, v189 offset:4096
    v_mfma_f32_32x32x16_bf16 v[52:67], v[152:155], v[136:139], v[52:67]
    ds_read_b64_tr_b16 v[168:169], v183 offset:12288
    v_and_b32 v188, 31, v0
    v_lshlrev_b32 v188, 3, v188
    s_waitcnt lgkmcnt(15)
    v_mfma_f32_32x32x16_bf16 v[68:83], v[156:159], v[132:135], v[68:83]
    ds_read_b64_tr_b16 v[170:171], v183 offset:13312
    ds_read_b64_tr_b16 v[172:173], v184 offset:12288
    s_lshl_b32 s45, s59, 9
    v_add_u32 v188, s45, v188
    v_mfma_f32_32x32x16_bf16 v[84:99], v[156:159], v[136:139], v[84:99]
    ds_read_b64_tr_b16 v[174:175], v184 offset:13312
    ds_read_b64 v[220:221], v188 offset:0
    ds_read_b64 v[222:223], v188 offset:256
    s_waitcnt lgkmcnt(15)
    v_mfma_f32_32x32x16_bf16 v[100:115], v[160:163], v[132:135], v[100:115]
    ds_read_b64_tr_b16 v[176:177], v185 offset:12288
    v_cmp_gt_u32 vcc, 32, v0
    v_mov_b32 v206, 0
    v_mfma_f32_32x32x16_bf16 v[116:131], v[160:163], v[136:139], v[116:131]
    ds_read_b64_tr_b16 v[178:179], v185 offset:13312
    v_mov_b32 v207, 0
    v_mov_b32 v210, 0
    s_waitcnt lgkmcnt(13)
    v_mfma_f32_32x32x16_bf16 v[4:19], v[164:167], v[140:143], v[4:19]
    s_waitcnt lgkmcnt(10)
    v_mfma_f32_32x32x16_bf16 v[20:35], v[164:167], v[144:147], v[20:35]
    s_waitcnt lgkmcnt(6)
    v_mfma_f32_32x32x16_bf16 v[36:51], v[168:171], v[140:143], v[36:51]
    s_waitcnt lgkmcnt(0)
    s_barrier
    v_add_u32 v180, 0xc000, v180
    v_add_u32 v182, 0xc000, v182
    v_add_u32 v183, 0xc000, v183
    v_add_u32 v184, 0xc000, v184
    v_add_u32 v185, 0xc000, v185
    v_mfma_f32_32x32x16_bf16 v[52:67], v[168:171], v[144:147], v[52:67]
    ds_read_b128 v[132:135], v180 offset:0
    ds_read_b64_tr_b16 v[148:149], v182 offset:0
    v_mov_b32 v211, 0
    v_mov_b32 v214, 0
    v_mfma_f32_32x32x16_bf16 v[68:83], v[172:175], v[140:143], v[68:83]
    ds_read_b64_tr_b16 v[150:151], v182 offset:1024
    ds_read_b128 v[136:139], v180 offset:4096
    v_mov_b32 v215, 0
    v_mov_b32 v218, 0
    v_mfma_f32_32x32x16_bf16 v[84:99], v[172:175], v[144:147], v[84:99]
    ds_read_b64_tr_b16 v[152:153], v183 offset:0
    ds_read_b64_tr_b16 v[154:155], v183 offset:1024
    v_mov_b32 v219, 0
    v_mov_b32 v198, 0
    v_mfma_f32_32x32x16_bf16 v[100:115], v[176:179], v[140:143], v[100:115]
    ds_read_b64_tr_b16 v[156:157], v184 offset:0
    ds_read_b64_tr_b16 v[158:159], v184 offset:1024
    v_mov_b32 v199, 0
    v_mov_b32 v202, 0
    v_mfma_f32_32x32x16_bf16 v[116:131], v[176:179], v[144:147], v[116:131]
    ds_read_b64_tr_b16 v[160:161], v185 offset:0
    ds_read_b64_tr_b16 v[162:163], v185 offset:1024
    v_mov_b32 v203, 0
    s_waitcnt lgkmcnt(7)
    v_mfma_f32_32x32x16_bf16 v[4:19], v[148:151], v[132:135], v[4:19]
    ds_read_b128 v[140:143], v180 offset:1024
    ds_read_b64_tr_b16 v[164:165], v182 offset:4096
    v_add_f32 v232, v232, v233
    v_add_f32 v234, v234, v235
    s_waitcnt lgkmcnt(8)
    v_mfma_f32_32x32x16_bf16 v[20:35], v[148:151], v[136:139], v[20:35]
    ds_read_b64_tr_b16 v[166:167], v182 offset:5120
    v_add_f32 v232, v232, v234
    v_cndmask_b32 v232, 0, v232, vcc
    s_waitcnt lgkmcnt(7)
    v_mfma_f32_32x32x16_bf16 v[36:51], v[152:155], v[132:135], v[36:51]
    ds_read_b128 v[144:147], v180 offset:5120
    v_cvt_pk_bf16_f32 v205, v232, 0
    v_lshlrev_b32 v192, 16, v205
    v_mfma_f32_32x32x16_bf16 v[52:67], v[152:155], v[136:139], v[52:67]
    ds_read_b64_tr_b16 v[168:169], v183 offset:4096
    v_sub_f32 v192, v232, v192
    v_cvt_pk_bf16_f32 v204, v232, v192
    s_waitcnt lgkmcnt(7)
    v_mfma_f32_32x32x16_bf16 v[68:83], v[156:159], v[132:135], v[68:83]
    ds_read_b64_tr_b16 v[170:171], v183 offset:5120
    ds_read_b64_tr_b16 v[172:173], v184 offset:4096
    v_add_f32 v236, v236, v237
    v_add_f32 v238, v238, v239
    v_mfma_f32_32x32x16_bf16 v[84:99], v[156:159], v[136:139], v[84:99]
    ds_read_b64_tr_b16 v[174:175], v184 offset:5120
    v_add_f32 v236, v236, v238
    v_cndmask_b32 v236, 0, v236, vcc
    s_waitcnt lgkmcnt(8)
    v_mfma_f32_32x32x16_bf16 v[100:115], v[160:163], v[132:135], v[100:115]
    ds_read_b64_tr_b16 v[176:177], v185 offset:4096
    v_cvt_pk_bf16_f32 v209, v236, 0
    v_lshlrev_b32 v192, 16, v209
    v_mfma_f32_32x32x16_bf16 v[116:131], v[160:163], v[136:139], v[116:131]
    ds_read_b64_tr_b16 v[178:179], v185 offset:5120
    v_sub_f32 v192, v236, v192
    v_cvt_pk_bf16_f32 v208, v236, v192
    s_waitcnt lgkmcnt(7)
    v_mfma_f32_32x32x16_bf16 v[4:19], v[164:167], v[140:143], v[4:19]
    ds_read_b128 v[132:135], v180 offset:2048
    ds_read_b64_tr_b16 v[148:149], v182 offset:8192
    v_add_f32 v240, v240, v241
    v_add_f32 v242, v242, v243
    s_waitcnt lgkmcnt(8)
    v_mfma_f32_32x32x16_bf16 v[20:35], v[164:167], v[144:147], v[20:35]
    ds_read_b64_tr_b16 v[150:151], v182 offset:9216
    v_add_f32 v240, v240, v242
    v_cndmask_b32 v240, 0, v240, vcc
    s_waitcnt lgkmcnt(7)
    v_mfma_f32_32x32x16_bf16 v[36:51], v[168:171], v[140:143], v[36:51]
    ds_read_b128 v[136:139], v180 offset:6144
    v_cvt_pk_bf16_f32 v213, v240, 0
    v_lshlrev_b32 v192, 16, v213
    v_mfma_f32_32x32x16_bf16 v[52:67], v[168:171], v[144:147], v[52:67]
    ds_read_b64_tr_b16 v[152:153], v183 offset:8192
    v_sub_f32 v192, v240, v192
    v_cvt_pk_bf16_f32 v212, v240, v192
    s_waitcnt lgkmcnt(7)
    v_mfma_f32_32x32x16_bf16 v[68:83], v[172:175], v[140:143], v[68:83]
    ds_read_b64_tr_b16 v[154:155], v183 offset:9216
    ds_read_b64_tr_b16 v[156:157], v184 offset:8192
    v_add_f32 v244, v244, v245
    v_add_f32 v246, v246, v247
    v_mfma_f32_32x32x16_bf16 v[84:99], v[172:175], v[144:147], v[84:99]
    ds_read_b64_tr_b16 v[158:159], v184 offset:9216
    v_add_f32 v244, v244, v246
    v_cndmask_b32 v244, 0, v244, vcc
    s_waitcnt lgkmcnt(8)
    v_mfma_f32_32x32x16_bf16 v[100:115], v[176:179], v[140:143], v[100:115]
    ds_read_b64_tr_b16 v[160:161], v185 offset:8192
    v_cvt_pk_bf16_f32 v217, v244, 0
    v_lshlrev_b32 v192, 16, v217
    v_mfma_f32_32x32x16_bf16 v[116:131], v[176:179], v[144:147], v[116:131]
    ds_read_b64_tr_b16 v[162:163], v185 offset:9216
    v_sub_f32 v192, v244, v192
    v_cvt_pk_bf16_f32 v216, v244, v192
    s_waitcnt lgkmcnt(7)
    v_mfma_f32_32x32x16_bf16 v[4:19], v[148:151], v[132:135], v[4:19]
    ds_read_b128 v[140:143], v180 offset:3072
    ds_read_b64_tr_b16 v[164:165], v182 offset:12288
    v_cndmask_b32 v193, 0, v220, vcc
    v_sub_f32 v193, 0, v193
    s_waitcnt lgkmcnt(8)
    v_mfma_f32_32x32x16_bf16 v[20:35], v[148:151], v[136:139], v[20:35]
    ds_read_b64_tr_b16 v[166:167], v182 offset:13312
    v_cvt_pk_bf16_f32 v196, v193, v193
    v_lshlrev_b32 v192, 16, v196
    s_waitcnt lgkmcnt(7)
    v_mfma_f32_32x32x16_bf16 v[36:51], v[152:155], v[132:135], v[36:51]
    ds_read_b128 v[144:147], v180 offset:7168
    v_sub_f32 v192, v193, v192
    v_cvt_pk_bf16_f32 v197, v192, 0
    v_mfma_f32_32x32x16_bf16 v[52:67], v[152:155], v[136:139], v[52:67]
    ds_read_b64_tr_b16 v[168:169], v183 offset:12288
    v_mul_f32 v248, 0xbfb8aa3b, v221
    v_rcp_f32 v249, v221
    s_waitcnt lgkmcnt(7)
    v_mfma_f32_32x32x16_bf16 v[68:83], v[156:159], v[132:135], v[68:83]
    ds_read_b64_tr_b16 v[170:171], v183 offset:13312
    ds_read_b64_tr_b16 v[172:173], v184 offset:12288
    v_cndmask_b32 v193, 0, v222, vcc
    v_sub_f32 v193, 0, v193
    v_mfma_f32_32x32x16_bf16 v[84:99], v[156:159], v[136:139], v[84:99]
    ds_read_b64_tr_b16 v[174:175], v184 offset:13312
    v_cvt_pk_bf16_f32 v200, v193, v193
    v_lshlrev_b32 v192, 16, v200
    s_waitcnt lgkmcnt(8)
    v_mfma_f32_32x32x16_bf16 v[100:115], v[160:163], v[132:135], v[100:115]
    ds_read_b64_tr_b16 v[176:177], v185 offset:12288
    v_sub_f32 v192, v193, v192
    v_cvt_pk_bf16_f32 v201, v192, 0
    v_mfma_f32_32x32x16_bf16 v[116:131], v[160:163], v[136:139], v[116:131]
    ds_read_b64_tr_b16 v[178:179], v185 offset:13312
    v_mul_f32 v250, 0xbfb8aa3b, v223
    v_rcp_f32 v251, v223
    s_waitcnt lgkmcnt(7)
    v_mfma_f32_32x32x16_bf16 v[4:19], v[164:167], v[140:143], v[4:19]
    s_waitcnt lgkmcnt(6)
    v_mfma_f32_32x32x16_bf16 v[20:35], v[164:167], v[144:147], v[20:35]
    s_waitcnt lgkmcnt(4)
    v_mfma_f32_32x32x16_bf16 v[36:51], v[168:171], v[140:143], v[36:51]
    v_mfma_f32_32x32x16_bf16 v[52:67], v[168:171], v[144:147], v[52:67]
    s_waitcnt lgkmcnt(2)
    v_mfma_f32_32x32x16_bf16 v[68:83], v[172:175], v[140:143], v[68:83]
    v_mfma_f32_32x32x16_bf16 v[84:99], v[172:175], v[144:147], v[84:99]
    s_waitcnt lgkmcnt(0)
    v_mfma_f32_32x32x16_bf16 v[100:115], v[176:179], v[140:143], v[100:115]
    v_mfma_f32_32x32x16_bf16 v[116:131], v[176:179], v[144:147], v[116:131]
    s_nop 1
    v_mfma_f32_32x32x16_bf16 v[4:19], v[204:207], v[196:199], v[4:19]
    v_mfma_f32_32x32x16_bf16 v[36:51], v[208:211], v[196:199], v[36:51]
    v_mfma_f32_32x32x16_bf16 v[68:83], v[212:215], v[196:199], v[68:83]
    v_mfma_f32_32x32x16_bf16 v[100:115], v[216:219], v[196:199], v[100:115]
    v_mfma_f32_32x32x16_bf16 v[20:35], v[204:207], v[200:203], v[20:35]
    v_mfma_f32_32x32x16_bf16 v[52:67], v[208:211], v[200:203], v[52:67]
    v_mfma_f32_32x32x16_bf16 v[84:99], v[212:215], v[200:203], v[84:99]
    v_mfma_f32_32x32x16_bf16 v[116:131], v[216:219], v[200:203], v[116:131]
    s_lshl_b32 s61, s56, 2
    s_lshl_b32 s45, s59, 1
    s_add_u32 s61, s61, s45
    s_mul_i32 s61, s61, 112
    s_lshl_b32 s45, s57, 3
    s_add_u32 s61, s61, s45
    s_add_u32 s61, s61, s44
    s_lshl_b32 s61, s61, 10
    s_add_u32 s61, s61, 8388608
    s_nop 7
    v_pk_mul_f32 v[4:5], v[4:5], v[248:249] op_sel_hi:[1,0]
    v_pk_mul_f32 v[6:7], v[6:7], v[248:249] op_sel_hi:[1,0]
    v_pk_mul_f32 v[12:13], v[12:13], v[248:249] op_sel_hi:[1,0]
    v_pk_mul_f32 v[14:15], v[14:15], v[248:249] op_sel_hi:[1,0]
    v_exp_f32 v4, v4
    v_exp_f32 v5, v5
    v_exp_f32 v6, v6
    v_exp_f32 v7, v7
    v_exp_f32 v12, v12
    v_exp_f32 v13, v13
    v_exp_f32 v14, v14
    v_exp_f32 v15, v15
    v_pk_fma_f32 v[4:5], v[4:5], v[248:249], v[248:249] op_sel:[0,1,1]
    v_pk_fma_f32 v[6:7], v[6:7], v[248:249], v[248:249] op_sel:[0,1,1]
    v_pk_fma_f32 v[12:13], v[12:13], v[248:249], v[248:249] op_sel:[0,1,1]
    v_pk_fma_f32 v[14:15], v[14:15], v[248:249], v[248:249] op_sel:[0,1,1]
    v_rcp_f32 v4, v4
    v_rcp_f32 v5, v5
    v_rcp_f32 v6, v6
    v_rcp_f32 v7, v7
    v_rcp_f32 v12, v12
    v_rcp_f32 v13, v13
    v_rcp_f32 v14, v14
    v_rcp_f32 v15, v15
    s_nop 0
    v_pk_mul_f32 v[4:5], v[4:5], v[8:9]
    v_pk_mul_f32 v[6:7], v[6:7], v[10:11]
    v_pk_mul_f32 v[12:13], v[12:13], v[16:17]
    v_pk_mul_f32 v[14:15], v[14:15], v[18:19]
    v_cvt_pk_bf16_f32 v224, v4, v5
    v_cvt_pk_bf16_f32 v225, v6, v7
    v_cvt_pk_bf16_f32 v226, v12, v13
    v_cvt_pk_bf16_f32 v227, v14, v15
    s_add_u32 s45, s61, 0
    buffer_store_dwordx4 v[224:227], v186, s[28:31], s45 offen sc1
    v_pk_mul_f32 v[36:37], v[36:37], v[248:249] op_sel_hi:[1,0]
    v_pk_mul_f32 v[38:39], v[38:39], v[248:249] op_sel_hi:[1,0]
    v_pk_mul_f32 v[44:45], v[44:45], v[248:249] op_sel_hi:[1,0]
    v_pk_mul_f32 v[46:47], v[46:47], v[248:249] op_sel_hi:[1,0]
    v_exp_f32 v36, v36
    v_exp_f32 v37, v37
    v_exp_f32 v38, v38
    v_exp_f32 v39, v39
    v_exp_f32 v44, v44
    v_exp_f32 v45, v45
    v_exp_f32 v46, v46
    v_exp_f32 v47, v47
    v_pk_fma_f32 v[36:37], v[36:37], v[248:249], v[248:249] op_sel:[0,1,1]
    v_pk_fma_f32 v[38:39], v[38:39], v[248:249], v[248:249] op_sel:[0,1,1]
    v_pk_fma_f32 v[44:45], v[44:45], v[248:249], v[248:249] op_sel:[0,1,1]
    v_pk_fma_f32 v[46:47], v[46:47], v[248:249], v[248:249] op_sel:[0,1,1]
    v_rcp_f32 v36, v36
    v_rcp_f32 v37, v37
    v_rcp_f32 v38, v38
    v_rcp_f32 v39, v39
    v_rcp_f32 v44, v44
    v_rcp_f32 v45, v45
    v_rcp_f32 v46, v46
    v_rcp_f32 v47, v47
    s_nop 0
    v_pk_mul_f32 v[36:37], v[36:37], v[40:41]
    v_pk_mul_f32 v[38:39], v[38:39], v[42:43]
    v_pk_mul_f32 v[44:45], v[44:45], v[48:49]
    v_pk_mul_f32 v[46:47], v[46:47], v[50:51]
    v_cvt_pk_bf16_f32 v228, v36, v37
    v_cvt_pk_bf16_f32 v229, v38, v39
    v_cvt_pk_bf16_f32 v230, v44, v45
    v_cvt_pk_bf16_f32 v231, v46, v47
    s_add_u32 s45, s61, 1024
    buffer_store_dwordx4 v[228:231], v186, s[28:31], s45 offen sc1
    v_pk_mul_f32 v[68:69], v[68:69], v[248:249] op_sel_hi:[1,0]
    v_pk_mul_f32 v[70:71], v[70:71], v[248:249] op_sel_hi:[1,0]
    v_pk_mul_f32 v[76:77], v[76:77], v[248:249] op_sel_hi:[1,0]
    v_pk_mul_f32 v[78:79], v[78:79], v[248:249] op_sel_hi:[1,0]
    v_exp_f32 v68, v68
    v_exp_f32 v69, v69
    v_exp_f32 v70, v70
    v_exp_f32 v71, v71
    v_exp_f32 v76, v76
    v_exp_f32 v77, v77
    v_exp_f32 v78, v78
    v_exp_f32 v79, v79
    v_pk_fma_f32 v[68:69], v[68:69], v[248:249], v[248:249] op_sel:[0,1,1]
    v_pk_fma_f32 v[70:71], v[70:71], v[248:249], v[248:249] op_sel:[0,1,1]
    v_pk_fma_f32 v[76:77], v[76:77], v[248:249], v[248:249] op_sel:[0,1,1]
    v_pk_fma_f32 v[78:79], v[78:79], v[248:249], v[248:249] op_sel:[0,1,1]
    v_rcp_f32 v68, v68
    v_rcp_f32 v69, v69
    v_rcp_f32 v70, v70
    v_rcp_f32 v71, v71
    v_rcp_f32 v76, v76
    v_rcp_f32 v77, v77
    v_rcp_f32 v78, v78
    v_rcp_f32 v79, v79
    s_nop 0
    v_pk_mul_f32 v[68:69], v[68:69], v[72:73]
    v_pk_mul_f32 v[70:71], v[70:71], v[74:75]
    v_pk_mul_f32 v[76:77], v[76:77], v[80:81]
    v_pk_mul_f32 v[78:79], v[78:79], v[82:83]
    v_cvt_pk_bf16_f32 v224, v68, v69
    v_cvt_pk_bf16_f32 v225, v70, v71
    v_cvt_pk_bf16_f32 v226, v76, v77
    v_cvt_pk_bf16_f32 v227, v78, v79
    s_add_u32 s45, s61, 2048
    buffer_store_dwordx4 v[224:227], v186, s[28:31], s45 offen sc1
    v_pk_mul_f32 v[100:101], v[100:101], v[248:249] op_sel_hi:[1,0]
    v_pk_mul_f32 v[102:103], v[102:103], v[248:249] op_sel_hi:[1,0]
    v_pk_mul_f32 v[108:109], v[108:109], v[248:249] op_sel_hi:[1,0]
    v_pk_mul_f32 v[110:111], v[110:111], v[248:249] op_sel_hi:[1,0]
    v_exp_f32 v100, v100
    v_exp_f32 v101, v101
    v_exp_f32 v102, v102
    v_exp_f32 v103, v103
    v_exp_f32 v108, v108
    v_exp_f32 v109, v109
    v_exp_f32 v110, v110
    v_exp_f32 v111, v111
    v_pk_fma_f32 v[100:101], v[100:101], v[248:249], v[248:249] op_sel:[0,1,1]
    v_pk_fma_f32 v[102:103], v[102:103], v[248:249], v[248:249] op_sel:[0,1,1]
    v_pk_fma_f32 v[108:109], v[108:109], v[248:249], v[248:249] op_sel:[0,1,1]
    v_pk_fma_f32 v[110:111], v[110:111], v[248:249], v[248:249] op_sel:[0,1,1]
    v_rcp_f32 v100, v100
    v_rcp_f32 v101, v101
    v_rcp_f32 v102, v102
    v_rcp_f32 v103, v103
    v_rcp_f32 v108, v108
    v_rcp_f32 v109, v109
    v_rcp_f32 v110, v110
    v_rcp_f32 v111, v111
    s_nop 0
    v_pk_mul_f32 v[100:101], v[100:101], v[104:105]
    v_pk_mul_f32 v[102:103], v[102:103], v[106:107]
    v_pk_mul_f32 v[108:109], v[108:109], v[112:113]
    v_pk_mul_f32 v[110:111], v[110:111], v[114:115]
    v_cvt_pk_bf16_f32 v228, v100, v101
    v_cvt_pk_bf16_f32 v229, v102, v103
    v_cvt_pk_bf16_f32 v230, v108, v109
    v_cvt_pk_bf16_f32 v231, v110, v111
    s_add_u32 s45, s61, 3072
    buffer_store_dwordx4 v[228:231], v186, s[28:31], s45 offen sc1
    v_pk_mul_f32 v[20:21], v[20:21], v[250:251] op_sel_hi:[1,0]
    v_pk_mul_f32 v[22:23], v[22:23], v[250:251] op_sel_hi:[1,0]
    v_pk_mul_f32 v[28:29], v[28:29], v[250:251] op_sel_hi:[1,0]
    v_pk_mul_f32 v[30:31], v[30:31], v[250:251] op_sel_hi:[1,0]
    v_exp_f32 v20, v20
    v_exp_f32 v21, v21
    v_exp_f32 v22, v22
    v_exp_f32 v23, v23
    v_exp_f32 v28, v28
    v_exp_f32 v29, v29
    v_exp_f32 v30, v30
    v_exp_f32 v31, v31
    v_pk_fma_f32 v[20:21], v[20:21], v[250:251], v[250:251] op_sel:[0,1,1]
    v_pk_fma_f32 v[22:23], v[22:23], v[250:251], v[250:251] op_sel:[0,1,1]
    v_pk_fma_f32 v[28:29], v[28:29], v[250:251], v[250:251] op_sel:[0,1,1]
    v_pk_fma_f32 v[30:31], v[30:31], v[250:251], v[250:251] op_sel:[0,1,1]
    v_rcp_f32 v20, v20
    v_rcp_f32 v21, v21
    v_rcp_f32 v22, v22
    v_rcp_f32 v23, v23
    v_rcp_f32 v28, v28
    v_rcp_f32 v29, v29
    v_rcp_f32 v30, v30
    v_rcp_f32 v31, v31
    s_nop 0
    v_pk_mul_f32 v[20:21], v[20:21], v[24:25]
    v_pk_mul_f32 v[22:23], v[22:23], v[26:27]
    v_pk_mul_f32 v[28:29], v[28:29], v[32:33]
    v_pk_mul_f32 v[30:31], v[30:31], v[34:35]
    v_cvt_pk_bf16_f32 v224, v20, v21
    v_cvt_pk_bf16_f32 v225, v22, v23
    v_cvt_pk_bf16_f32 v226, v28, v29
    v_cvt_pk_bf16_f32 v227, v30, v31
    s_add_u32 s45, s61, 114688
    buffer_store_dwordx4 v[224:227], v186, s[28:31], s45 offen sc1
    v_pk_mul_f32 v[52:53], v[52:53], v[250:251] op_sel_hi:[1,0]
    v_pk_mul_f32 v[54:55], v[54:55], v[250:251] op_sel_hi:[1,0]
    v_pk_mul_f32 v[60:61], v[60:61], v[250:251] op_sel_hi:[1,0]
    v_pk_mul_f32 v[62:63], v[62:63], v[250:251] op_sel_hi:[1,0]
    v_exp_f32 v52, v52
    v_exp_f32 v53, v53
    v_exp_f32 v54, v54
    v_exp_f32 v55, v55
    v_exp_f32 v60, v60
    v_exp_f32 v61, v61
    v_exp_f32 v62, v62
    v_exp_f32 v63, v63
    v_pk_fma_f32 v[52:53], v[52:53], v[250:251], v[250:251] op_sel:[0,1,1]
    v_pk_fma_f32 v[54:55], v[54:55], v[250:251], v[250:251] op_sel:[0,1,1]
    v_pk_fma_f32 v[60:61], v[60:61], v[250:251], v[250:251] op_sel:[0,1,1]
    v_pk_fma_f32 v[62:63], v[62:63], v[250:251], v[250:251] op_sel:[0,1,1]
    v_rcp_f32 v52, v52
    v_rcp_f32 v53, v53
    v_rcp_f32 v54, v54
    v_rcp_f32 v55, v55
    v_rcp_f32 v60, v60
    v_rcp_f32 v61, v61
    v_rcp_f32 v62, v62
    v_rcp_f32 v63, v63
    s_nop 0
    v_pk_mul_f32 v[52:53], v[52:53], v[56:57]
    v_pk_mul_f32 v[54:55], v[54:55], v[58:59]
    v_pk_mul_f32 v[60:61], v[60:61], v[64:65]
    v_pk_mul_f32 v[62:63], v[62:63], v[66:67]
    v_cvt_pk_bf16_f32 v228, v52, v53
    v_cvt_pk_bf16_f32 v229, v54, v55
    v_cvt_pk_bf16_f32 v230, v60, v61
    v_cvt_pk_bf16_f32 v231, v62, v63
    s_add_u32 s45, s61, 115712
    buffer_store_dwordx4 v[228:231], v186, s[28:31], s45 offen sc1
    v_pk_mul_f32 v[84:85], v[84:85], v[250:251] op_sel_hi:[1,0]
    v_pk_mul_f32 v[86:87], v[86:87], v[250:251] op_sel_hi:[1,0]
    v_pk_mul_f32 v[92:93], v[92:93], v[250:251] op_sel_hi:[1,0]
    v_pk_mul_f32 v[94:95], v[94:95], v[250:251] op_sel_hi:[1,0]
    v_exp_f32 v84, v84
    v_exp_f32 v85, v85
    v_exp_f32 v86, v86
    v_exp_f32 v87, v87
    v_exp_f32 v92, v92
    v_exp_f32 v93, v93
    v_exp_f32 v94, v94
    v_exp_f32 v95, v95
    v_pk_fma_f32 v[84:85], v[84:85], v[250:251], v[250:251] op_sel:[0,1,1]
    v_pk_fma_f32 v[86:87], v[86:87], v[250:251], v[250:251] op_sel:[0,1,1]
    v_pk_fma_f32 v[92:93], v[92:93], v[250:251], v[250:251] op_sel:[0,1,1]
    v_pk_fma_f32 v[94:95], v[94:95], v[250:251], v[250:251] op_sel:[0,1,1]
    v_rcp_f32 v84, v84
    v_rcp_f32 v85, v85
    v_rcp_f32 v86, v86
    v_rcp_f32 v87, v87
    v_rcp_f32 v92, v92
    v_rcp_f32 v93, v93
    v_rcp_f32 v94, v94
    v_rcp_f32 v95, v95
    s_nop 0
    v_pk_mul_f32 v[84:85], v[84:85], v[88:89]
    v_pk_mul_f32 v[86:87], v[86:87], v[90:91]
    v_pk_mul_f32 v[92:93], v[92:93], v[96:97]
    v_pk_mul_f32 v[94:95], v[94:95], v[98:99]
    v_cvt_pk_bf16_f32 v224, v84, v85
    v_cvt_pk_bf16_f32 v225, v86, v87
    v_cvt_pk_bf16_f32 v226, v92, v93
    v_cvt_pk_bf16_f32 v227, v94, v95
    s_add_u32 s45, s61, 116736
    buffer_store_dwordx4 v[224:227], v186, s[28:31], s45 offen sc1
    v_pk_mul_f32 v[116:117], v[116:117], v[250:251] op_sel_hi:[1,0]
    v_pk_mul_f32 v[118:119], v[118:119], v[250:251] op_sel_hi:[1,0]
    v_pk_mul_f32 v[124:125], v[124:125], v[250:251] op_sel_hi:[1,0]
    v_pk_mul_f32 v[126:127], v[126:127], v[250:251] op_sel_hi:[1,0]
    v_exp_f32 v116, v116
    v_exp_f32 v117, v117
    v_exp_f32 v118, v118
    v_exp_f32 v119, v119
    v_exp_f32 v124, v124
    v_exp_f32 v125, v125
    v_exp_f32 v126, v126
    v_exp_f32 v127, v127
    v_pk_fma_f32 v[116:117], v[116:117], v[250:251], v[250:251] op_sel:[0,1,1]
    v_pk_fma_f32 v[118:119], v[118:119], v[250:251], v[250:251] op_sel:[0,1,1]
    v_pk_fma_f32 v[124:125], v[124:125], v[250:251], v[250:251] op_sel:[0,1,1]
    v_pk_fma_f32 v[126:127], v[126:127], v[250:251], v[250:251] op_sel:[0,1,1]
    v_rcp_f32 v116, v116
    v_rcp_f32 v117, v117
    v_rcp_f32 v118, v118
    v_rcp_f32 v119, v119
    v_rcp_f32 v124, v124
    v_rcp_f32 v125, v125
    v_rcp_f32 v126, v126
    v_rcp_f32 v127, v127
    s_nop 0
    v_pk_mul_f32 v[116:117], v[116:117], v[120:121]
    v_pk_mul_f32 v[118:119], v[118:119], v[122:123]
    v_pk_mul_f32 v[124:125], v[124:125], v[128:129]
    v_pk_mul_f32 v[126:127], v[126:127], v[130:131]
    v_cvt_pk_bf16_f32 v228, v116, v117
    v_cvt_pk_bf16_f32 v229, v118, v119
    v_cvt_pk_bf16_f32 v230, v124, v125
    v_cvt_pk_bf16_f32 v231, v126, v127
    s_add_u32 s45, s61, 117760
    buffer_store_dwordx4 v[228:231], v186, s[28:31], s45 offen sc1
P3_DONE:
    s_and_b32 s44, s2, 7
    s_lshr_b32 s45, s2, 3
    s_lshl_b32 s56, s44, 2
    s_and_b32 s46, s45, 3
    s_add_u32 s56, s56, s46
    s_lshr_b32 s57, s45, 2
    s_and_b32 s58, s45, 3
    s_mul_i32 s58, s58, 2
    s_add_u32 s58, s58, s57
    s_and_b32 s55, s44, 3
    s_lshl_b32 s55, s55, 2
    s_and_b32 s46, s45, 3
    s_add_u32 s55, s55, s46
    s_lshl_b32 s55, s55, 4
    s_lshr_b32 s46, s44, 2
    s_mul_i32 s46, s46, 7
    s_lshr_b32 s47, s45, 2
    s_add_u32 s46, s46, s47
    s_cmp_ge_u32 s2, 224
    s_cselect_b32 s46, 15, s46
    s_add_u32 s55, s55, s46
    s_cmp_ge_u32 s24, 4
    s_cbranch_scc0 P4_CONS
    s_waitcnt vmcnt(0)
    s_barrier
    s_barrier
    v_lshlrev_b32 v2, 4, v0
    v_lshrrev_b32 v4, 3, v0
    v_lshlrev_b32 v4, 10, v4
    v_bfe_u32 v5, v0, 4, 1
    v_lshlrev_b32 v5, 2, v5
    v_and_b32 v6, 7, v0
    v_xor_b32 v5, v5, v6
    v_lshl_add_u32 v3, v5, 4, v4
    s_mov_b32 s32, s16
    s_and_b32 s33, s17, 0xffff
    s_mov_b32 s34, 1835008
    s_mov_b32 s35, 0x20000
    s_and_b32 s44, s25, 1
    s_lshr_b32 s45, s25, 1
    s_lshl_b32 s59, s56, 1
    s_add_u32 s59, s59, s44
    s_mul_i32 s59, s59, 114688
    s_lshl_b32 s46, s45, 12
    s_add_u32 s59, s59, s46
    s_add_u32 s59, s59, 8388608
    s_lshl_b32 s61, s44, 13
    s_add_u32 s61, s61, s46
    s_lshl_b32 s60, s25, 15
    s_lshl_b32 s46, s57, 7
    s_add_u32 s60, s60, s46
    s_lshl_b32 s62, s25, 12
    s_mov_b32 s63, s58
    s_mov_b32 s3, s58
    s_lshl_b32 s50, s3, 17
    s_add_u32 s50, s50, s60
    s_add_u32 s3, s3, 1
    s_cmp_eq_u32 s3, 14
    s_cselect_b32 s3, 0, s3
    s_add_u32 m0, s62, 57344
    s_nop 0
    buffer_load_dwordx4 v3, s[32:35], s50 offen lds
    s_add_u32 s50, s50, 8192
    s_add_u32 m0, s62, 58368
    s_nop 0
    buffer_load_dwordx4 v3, s[32:35], s50 offen lds
    s_add_u32 s50, s50, 8192
    s_add_u32 m0, s62, 59392
    s_nop 0
    buffer_load_dwordx4 v3, s[32:35], s50 offen lds
    s_add_u32 s50, s50, 8192
    s_add_u32 m0, s62, 60416
    s_nop 0
    buffer_load_dwordx4 v3, s[32:35], s50 offen lds
    s_lshl_b32 s50, s3, 17
    s_add_u32 s50, s50, s60
    s_add_u32 s3, s3, 1
    s_cmp_eq_u32 s3, 14
    s_cselect_b32 s3, 0, s3
    s_add_u32 m0, s62, 73728
    s_nop 0
    buffer_load_dwordx4 v3, s[32:35], s50 offen lds
    s_add_u32 s50, s50, 8192
    s_add_u32 m0, s62, 74752
    s_nop 0
    buffer_load_dwordx4 v3, s[32:35], s50 offen lds
    s_add_u32 s50, s50, 8192
    s_add_u32 m0, s62, 75776
    s_nop 0
    buffer_load_dwordx4 v3, s[32:35], s50 offen lds
    s_add_u32 s50, s50, 8192
    s_add_u32 m0, s62, 76800
    s_nop 0
    buffer_load_dwordx4 v3, s[32:35], s50 offen lds
    s_lshl_b32 s50, s3, 17
    s_add_u32 s50, s50, s60
    s_add_u32 s3, s3, 1
    s_cmp_eq_u32 s3, 14
    s_cselect_b32 s3, 0, s3
    s_add_u32 m0, s62, 90112
    s_nop 0
    buffer_load_dwordx4 v3, s[32:35], s50 offen lds
    s_add_u32 s50, s50, 8192
    s_add_u32 m0, s62, 91136
    s_nop 0
    buffer_load_dwordx4 v3, s[32:35], s50 offen lds
    s_add_u32 s50, s50, 8192
    s_add_u32 m0, s62, 92160
    s_nop 0
    buffer_load_dwordx4 v3, s[32:35], s50 offen lds
    s_add_u32 s50, s50, 8192
    s_add_u32 m0, s62, 93184
    s_nop 0
    buffer_load_dwordx4 v3, s[32:35], s50 offen lds
    s_lshl_b32 s50, s3, 17
    s_add_u32 s50, s50, s60
    s_add_u32 s3, s3, 1
    s_cmp_eq_u32 s3, 14
    s_cselect_b32 s3, 0, s3
    s_add_u32 m0, s62, 106496
    s_nop 0
    buffer_load_dwordx4 v3, s[32:35], s50 offen lds
    s_add_u32 s50, s50, 8192
    s_add_u32 m0, s62, 107520
    s_nop 0
    buffer_load_dwordx4 v3, s[32:35], s50 offen lds
    s_add_u32 s50, s50, 8192
    s_add_u32 m0, s62, 108544
    s_nop 0
    buffer_load_dwordx4 v3, s[32:35], s50 offen lds
    s_add_u32 s50, s50, 8192
    s_add_u32 m0, s62, 109568
    s_nop 0
    buffer_load_dwordx4 v3, s[32:35], s50 offen lds
    s_lshl_b32 s50, s3, 17
    s_add_u32 s50, s50, s60
    s_add_u32 s3, s3, 1
    s_cmp_eq_u32 s3, 14
    s_cselect_b32 s3, 0, s3
    s_add_u32 m0, s62, 122880
    s_nop 0
    buffer_load_dwordx4 v3, s[32:35], s50 offen lds
    s_add_u32 s50, s50, 8192
    s_add_u32 m0, s62, 123904
    s_nop 0
    buffer_load_dwordx4 v3, s[32:35], s50 offen lds
    s_add_u32 s50, s50, 8192
    s_add_u32 m0, s62, 124928
    s_nop 0
    buffer_load_dwordx4 v3, s[32:35], s50 offen lds
    s_add_u32 s50, s50, 8192
    s_add_u32 m0, s62, 125952
    s_nop 0
    buffer_load_dwordx4 v3, s[32:35], s50 offen lds
    s_lshl_b32 s50, s3, 17
    s_add_u32 s50, s50, s60
    s_add_u32 s3, s3, 1
    s_cmp_eq_u32 s3, 14
    s_cselect_b32 s3, 0, s3
    s_add_u32 m0, s62, 139264
    s_nop 0
    buffer_load_dwordx4 v3, s[32:35], s50 offen lds
    s_add_u32 s50, s50, 8192
    s_add_u32 m0, s62, 140288
    s_nop 0
    buffer_load_dwordx4 v3, s[32:35], s50 offen lds
    s_add_u32 s50, s50, 8192
    s_add_u32 m0, s62, 141312
    s_nop 0
    buffer_load_dwordx4 v3, s[32:35], s50 offen lds
    s_add_u32 s50, s50, 8192
    s_add_u32 m0, s62, 142336
    s_nop 0
    buffer_load_dwordx4 v3, s[32:35], s50 offen lds
    s_barrier
    s_lshl_b32 s27, s63, 13
    s_add_u32 s27, s27, s59
    s_add_u32 m0, s61, 8192
    s_add_u32 s63, s63, 1
    buffer_load_dwordx4 v2, s[28:31], s27 offen offset:0 sc1 lds
    buffer_load_dwordx4 v2, s[28:31], s27 offen offset:1024 sc1 lds
    buffer_load_dwordx4 v2, s[28:31], s27 offen offset:2048 sc1 lds
    buffer_load_dwordx4 v2, s[28:31], s27 offen offset:3072 sc1 lds
    s_cmp_eq_u32 s63, 14
    s_cselect_b32 s63, 0, s63
    s_lshl_b32 s27, s63, 13
    s_add_u32 s27, s27, s59
    s_add_u32 m0, s61, 24576
    s_add_u32 s63, s63, 1
    buffer_load_dwordx4 v2, s[28:31], s27 offen offset:0 sc1 lds
    buffer_load_dwordx4 v2, s[28:31], s27 offen offset:1024 sc1 lds
    buffer_load_dwordx4 v2, s[28:31], s27 offen offset:2048 sc1 lds
    buffer_load_dwordx4 v2, s[28:31], s27 offen offset:3072 sc1 lds
    s_cmp_eq_u32 s63, 14
    s_cselect_b32 s63, 0, s63
    s_waitcnt vmcnt(4)
    s_barrier
    s_lshl_b32 s27, s63, 13
    s_add_u32 s27, s27, s59
    s_add_u32 m0, s61, 40960
    s_add_u32 s63, s63, 1
    buffer_load_dwordx4 v2, s[28:31], s27 offen offset:0 sc1 lds
    buffer_load_dwordx4 v2, s[28:31], s27 offen offset:1024 sc1 lds
    buffer_load_dwordx4 v2, s[28:31], s27 offen offset:2048 sc1 lds
    buffer_load_dwordx4 v2, s[28:31], s27 offen offset:3072 sc1 lds
    s_cmp_eq_u32 s63, 14
    s_cselect_b32 s63, 0, s63
    s_waitcnt vmcnt(4)
    s_barrier
    s_lshl_b32 s27, s63, 13
    s_add_u32 s27, s27, s59
    s_add_u32 m0, s61, 8192
    s_add_u32 s63, s63, 1
    buffer_load_dwordx4 v2, s[28:31], s27 offen offset:0 sc1 lds
    buffer_load_dwordx4 v2, s[28:31], s27 offen offset:1024 sc1 lds
    buffer_load_dwordx4 v2, s[28:31], s27 offen offset:2048 sc1 lds
    buffer_load_dwordx4 v2, s[28:31], s27 offen offset:3072 sc1 lds
    s_cmp_eq_u32 s63, 14
    s_cselect_b32 s63, 0, s63
    s_lshl_b32 s50, s3, 17
    s_add_u32 s50, s50, s60
    s_add_u32 s3, s3, 1
    s_cmp_eq_u32 s3, 14
    s_cselect_b32 s3, 0, s3
    s_add_u32 m0, s62, 57344
    s_nop 0
    buffer_load_dwordx4 v3, s[32:35], s50 offen lds
    s_add_u32 s50, s50, 8192
    s_add_u32 m0, s62, 58368
    s_nop 0
    buffer_load_dwordx4 v3, s[32:35], s50 offen lds
    s_add_u32 s50, s50, 8192
    s_add_u32 m0, s62, 59392
    s_nop 0
    buffer_load_dwordx4 v3, s[32:35], s50 offen lds
    s_add_u32 s50, s50, 8192
    s_add_u32 m0, s62, 60416
    s_nop 0
    buffer_load_dwordx4 v3, s[32:35], s50 offen lds
    s_waitcnt vmcnt(8)
    s_barrier
    s_lshl_b32 s27, s63, 13
    s_add_u32 s27, s27, s59
    s_add_u32 m0, s61, 24576
    s_add_u32 s63, s63, 1
    buffer_load_dwordx4 v2, s[28:31], s27 offen offset:0 sc1 lds
    buffer_load_dwordx4 v2, s[28:31], s27 offen offset:1024 sc1 lds
    buffer_load_dwordx4 v2, s[28:31], s27 offen offset:2048 sc1 lds
    buffer_load_dwordx4 v2, s[28:31], s27 offen offset:3072 sc1 lds
    s_cmp_eq_u32 s63, 14
    s_cselect_b32 s63, 0, s63
    s_lshl_b32 s50, s3, 17
    s_add_u32 s50, s50, s60
    s_add_u32 s3, s3, 1
    s_cmp_eq_u32 s3, 14
    s_cselect_b32 s3, 0, s3
    s_add_u32 m0, s62, 73728
    s_nop 0
    buffer_load_dwordx4 v3, s[32:35], s50 offen lds
    s_add_u32 s50, s50, 8192
    s_add_u32 m0, s62, 74752
    s_nop 0
    buffer_load_dwordx4 v3, s[32:35], s50 offen lds
    s_add_u32 s50, s50, 8192
    s_add_u32 m0, s62, 75776
    s_nop 0
    buffer_load_dwordx4 v3, s[32:35], s50 offen lds
    s_add_u32 s50, s50, 8192
    s_add_u32 m0, s62, 76800
    s_nop 0
    buffer_load_dwordx4 v3, s[32:35], s50 offen lds
    s_waitcnt vmcnt(12)
    s_barrier
    s_lshl_b32 s27, s63, 13
    s_add_u32 s27, s27, s59
    s_add_u32 m0, s61, 40960
    s_add_u32 s63, s63, 1
    buffer_load_dwordx4 v2, s[28:31], s27 offen offset:0 sc1 lds
    buffer_load_dwordx4 v2, s[28:31], s27 offen offset:1024 sc1 lds
    buffer_load_dwordx4 v2, s[28:31], s27 offen offset:2048 sc1 lds
    buffer_load_dwordx4 v2, s[28:31], s27 offen offset:3072 sc1 lds
    s_cmp_eq_u32 s63, 14
    s_cselect_b32 s63, 0, s63
    s_lshl_b32 s50, s3, 17
    s_add_u32 s50, s50, s60
    s_add_u32 s3, s3, 1
    s_cmp_eq_u32 s3, 14
    s_cselect_b32 s3, 0, s3
    s_add_u32 m0, s62, 90112
    s_nop 0
    buffer_load_dwordx4 v3, s[32:35], s50 offen lds
    s_add_u32 s50, s50, 8192
    s_add_u32 m0, s62, 91136
    s_nop 0
    buffer_load_dwordx4 v3, s[32:35], s50 offen lds
    s_add_u32 s50, s50, 8192
    s_add_u32 m0, s62, 92160
    s_nop 0
    buffer_load_dwordx4 v3, s[32:35], s50 offen lds
    s_add_u32 s50, s50, 8192
    s_add_u32 m0, s62, 93184
    s_nop 0
    buffer_load_dwordx4 v3, s[32:35], s50 offen lds
    s_waitcnt vmcnt(12)
    s_barrier
    s_lshl_b32 s27, s63, 13
    s_add_u32 s27, s27, s59
    s_add_u32 m0, s61, 8192
    s_add_u32 s63, s63, 1
    buffer_load_dwordx4 v2, s[28:31], s27 offen offset:0 sc1 lds
    buffer_load_dwordx4 v2, s[28:31], s27 offen offset:1024 sc1 lds
    buffer_load_dwordx4 v2, s[28:31], s27 offen offset:2048 sc1 lds
    buffer_load_dwordx4 v2, s[28:31], s27 offen offset:3072 sc1 lds
    s_cmp_eq_u32 s63, 14
    s_cselect_b32 s63, 0, s63
    s_lshl_b32 s50, s3, 17
    s_add_u32 s50, s50, s60
    s_add_u32 s3, s3, 1
    s_cmp_eq_u32 s3, 14
    s_cselect_b32 s3, 0, s3
    s_add_u32 m0, s62, 106496
    s_nop 0
    buffer_load_dwordx4 v3, s[32:35], s50 offen lds
    s_add_u32 s50, s50, 8192
    s_add_u32 m0, s62, 107520
    s_nop 0
    buffer_load_dwordx4 v3, s[32:35], s50 offen lds
    s_add_u32 s50, s50, 8192
    s_add_u32 m0, s62, 108544
    s_nop 0
    buffer_load_dwordx4 v3, s[32:35], s50 offen lds
    s_add_u32 s50, s50, 8192
    s_add_u32 m0, s62, 109568
    s_nop 0
    buffer_load_dwordx4 v3, s[32:35], s50 offen lds
    s_waitcnt vmcnt(12)
    s_barrier
    s_lshl_b32 s27, s63, 13
    s_add_u32 s27, s27, s59
    s_add_u32 m0, s61, 24576
    s_add_u32 s63, s63, 1
    buffer_load_dwordx4 v2, s[28:31], s27 offen offset:0 sc1 lds
    buffer_load_dwordx4 v2, s[28:31], s27 offen offset:1024 sc1 lds
    buffer_load_dwordx4 v2, s[28:31], s27 offen offset:2048 sc1 lds
    buffer_load_dwordx4 v2, s[28:31], s27 offen offset:3072 sc1 lds
    s_cmp_eq_u32 s63, 14
    s_cselect_b32 s63, 0, s63
    s_lshl_b32 s50, s3, 17
    s_add_u32 s50, s50, s60
    s_add_u32 s3, s3, 1
    s_cmp_eq_u32 s3, 14
    s_cselect_b32 s3, 0, s3
    s_add_u32 m0, s62, 122880
    s_nop 0
    buffer_load_dwordx4 v3, s[32:35], s50 offen lds
    s_add_u32 s50, s50, 8192
    s_add_u32 m0, s62, 123904
    s_nop 0
    buffer_load_dwordx4 v3, s[32:35], s50 offen lds
    s_add_u32 s50, s50, 8192
    s_add_u32 m0, s62, 124928
    s_nop 0
    buffer_load_dwordx4 v3, s[32:35], s50 offen lds
    s_add_u32 s50, s50, 8192
    s_add_u32 m0, s62, 125952
    s_nop 0
    buffer_load_dwordx4 v3, s[32:35], s50 offen lds
    s_waitcnt vmcnt(12)
    s_barrier
    s_lshl_b32 s27, s63, 13
    s_add_u32 s27, s27, s59
    s_add_u32 m0, s61, 40960
    s_add_u32 s63, s63, 1
    buffer_load_dwordx4 v2, s[28:31], s27 offen offset:0 sc1 lds
    buffer_load_dwordx4 v2, s[28:31], s27 offen offset:1024 sc1 lds
    buffer_load_dwordx4 v2, s[28:31], s27 offen offset:2048 sc1 lds
    buffer_load_dwordx4 v2, s[28:31], s27 offen offset:3072 sc1 lds
    s_cmp_eq_u32 s63, 14
    s_cselect_b32 s63, 0, s63
    s_lshl_b32 s50, s3, 17
    s_add_u32 s50, s50, s60
    s_add_u32 s3, s3, 1
    s_cmp_eq_u32 s3, 14
    s_cselect_b32 s3, 0, s3
    s_add_u32 m0, s62, 139264
    s_nop 0
    buffer_load_dwordx4 v3, s[32:35], s50 offen lds
    s_add_u32 s50, s50, 8192
    s_add_u32 m0, s62, 140288
    s_nop 0
    buffer_load_dwordx4 v3, s[32:35], s50 offen lds
    s_add_u32 s50, s50, 8192
    s_add_u32 m0, s62, 141312
    s_nop 0
    buffer_load_dwordx4 v3, s[32:35], s50 offen lds
    s_add_u32 s50, s50, 8192
    s_add_u32 m0, s62, 142336
    s_nop 0
    buffer_load_dwordx4 v3, s[32:35], s50 offen lds
    s_waitcnt vmcnt(12)
    s_barrier
    s_lshl_b32 s27, s63, 13
    s_add_u32 s27, s27, s59
    s_add_u32 m0, s61, 8192
    s_add_u32 s63, s63, 1
    buffer_load_dwordx4 v2, s[28:31], s27 offen offset:0 sc1 lds
    buffer_load_dwordx4 v2, s[28:31], s27 offen offset:1024 sc1 lds
    buffer_load_dwordx4 v2, s[28:31], s27 offen offset:2048 sc1 lds
    buffer_load_dwordx4 v2, s[28:31], s27 offen offset:3072 sc1 lds
    s_cmp_eq_u32 s63, 14
    s_cselect_b32 s63, 0, s63
    s_lshl_b32 s50, s3, 17
    s_add_u32 s50, s50, s60
    s_add_u32 s3, s3, 1
    s_cmp_eq_u32 s3, 14
    s_cselect_b32 s3, 0, s3
    s_add_u32 m0, s62, 57344
    s_nop 0
    buffer_load_dwordx4 v3, s[32:35], s50 offen lds
    s_add_u32 s50, s50, 8192
    s_add_u32 m0, s62, 58368
    s_nop 0
    buffer_load_dwordx4 v3, s[32:35], s50 offen lds
    s_add_u32 s50, s50, 8192
    s_add_u32 m0, s62, 59392
    s_nop 0
    buffer_load_dwordx4 v3, s[32:35], s50 offen lds
    s_add_u32 s50, s50, 8192
    s_add_u32 m0, s62, 60416
    s_nop 0
    buffer_load_dwordx4 v3, s[32:35], s50 offen lds
    s_waitcnt vmcnt(12)
    s_barrier
    s_lshl_b32 s27, s63, 13
    s_add_u32 s27, s27, s59
    s_add_u32 m0, s61, 24576
    s_add_u32 s63, s63, 1
    buffer_load_dwordx4 v2, s[28:31], s27 offen offset:0 sc1 lds
    buffer_load_dwordx4 v2, s[28:31], s27 offen offset:1024 sc1 lds
    buffer_load_dwordx4 v2, s[28:31], s27 offen offset:2048 sc1 lds
    buffer_load_dwordx4 v2, s[28:31], s27 offen offset:3072 sc1 lds
    s_cmp_eq_u32 s63, 14
    s_cselect_b32 s63, 0, s63
    s_lshl_b32 s50, s3, 17
    s_add_u32 s50, s50, s60
    s_add_u32 s3, s3, 1
    s_cmp_eq_u32 s3, 14
    s_cselect_b32 s3, 0, s3
    s_add_u32 m0, s62, 73728
    s_nop 0
    buffer_load_dwordx4 v3, s[32:35], s50 offen lds
    s_add_u32 s50, s50, 8192
    s_add_u32 m0, s62, 74752
    s_nop 0
    buffer_load_dwordx4 v3, s[32:35], s50 offen lds
    s_add_u32 s50, s50, 8192
    s_add_u32 m0, s62, 75776
    s_nop 0
    buffer_load_dwordx4 v3, s[32:35], s50 offen lds
    s_add_u32 s50, s50, 8192
    s_add_u32 m0, s62, 76800
    s_nop 0
    buffer_load_dwordx4 v3, s[32:35], s50 offen lds
    s_waitcnt vmcnt(12)
    s_barrier
    s_lshl_b32 s27, s63, 13
    s_add_u32 s27, s27, s59
    s_add_u32 m0, s61, 40960
    s_add_u32 s63, s63, 1
    buffer_load_dwordx4 v2, s[28:31], s27 offen offset:0 sc1 lds
    buffer_load_dwordx4 v2, s[28:31], s27 offen offset:1024 sc1 lds
    buffer_load_dwordx4 v2, s[28:31], s27 offen offset:2048 sc1 lds
    buffer_load_dwordx4 v2, s[28:31], s27 offen offset:3072 sc1 lds
    s_cmp_eq_u32 s63, 14
    s_cselect_b32 s63, 0, s63
    s_waitcnt vmcnt(8)
    s_barrier
    s_lshl_b32 s27, s63, 13
    s_add_u32 s27, s27, s59
    s_add_u32 m0, s61, 8192
    s_add_u32 s63, s63, 1
    buffer_load_dwordx4 v2, s[28:31], s27 offen offset:0 sc1 lds
    buffer_load_dwordx4 v2, s[28:31], s27 offen offset:1024 sc1 lds
    buffer_load_dwordx4 v2, s[28:31], s27 offen offset:2048 sc1 lds
    buffer_load_dwordx4 v2, s[28:31], s27 offen offset:3072 sc1 lds
    s_cmp_eq_u32 s63, 14
    s_cselect_b32 s63, 0, s63
    s_waitcnt vmcnt(4)
    s_barrier
    s_lshl_b32 s27, s63, 13
    s_add_u32 s27, s27, s59
    s_add_u32 m0, s61, 24576
    s_add_u32 s63, s63, 1
    buffer_load_dwordx4 v2, s[28:31], s27 offen offset:0 sc1 lds
    buffer_load_dwordx4 v2, s[28:31], s27 offen offset:1024 sc1 lds
    buffer_load_dwordx4 v2, s[28:31], s27 offen offset:2048 sc1 lds
    buffer_load_dwordx4 v2, s[28:31], s27 offen offset:3072 sc1 lds
    s_cmp_eq_u32 s63, 14
    s_cselect_b32 s63, 0, s63
    s_waitcnt vmcnt(4)
    s_barrier
    s_waitcnt vmcnt(0)
    s_barrier
    s_endpgm
P4_CONS:
    s_waitcnt vmcnt(0)
    s_barrier
    s_cmp_eq_u32 s24, 0
    s_cbranch_scc0 SIG3C
    s_lshl_b32 s44, s55, 7
    s_add_u32 s44, s44, 8192000
    v_mov_b32 v56, 0
    v_mov_b32 v57, s26
    v_cmp_eq_u32 vcc, 0, v0
    s_and_saveexec_b64 s[48:49], vcc
    buffer_store_dword v57, v56, s[28:31], s44 offen sc1
    s_mov_b64 exec, s[48:49]
SIG3C:
    s_barrier
    s_and_b32 s59, s24, 1
    s_lshr_b32 s60, s24, 1
    v_lshlrev_b32 v54, 4, v0
    s_lshl_b32 s44, s59, 13
    s_add_u32 s44, s44, 8192
    v_add_u32 v52, s44, v54
    v_lshrrev_b32 v56, 5, v0
    v_lshlrev_b32 v56, 3, v56
    v_bfe_u32 v57, v0, 2, 2
    v_add_u32 v56, v56, v57
    v_lshlrev_b32 v56, 7, v56
    v_bfe_u32 v57, v0, 3, 1
    v_lshl_add_u32 v56, v57, 6, v56
    v_bfe_u32 v57, v0, 4, 1
    v_lshl_add_u32 v56, v57, 5, v56
    v_and_b32 v57, 1, v0
    v_lshl_add_u32 v56, v57, 4, v56
    v_bfe_u32 v57, v0, 1, 1
    v_lshl_add_u32 v56, v57, 3, v56
    s_lshl_b32 s44, s60, 6
    v_xor_b32 v53, s44, v56
    v_add_u32 v53, 57344, v53
    v_mov_b32 v4, 0
    v_mov_b32 v5, 0
    v_mov_b32 v6, 0
    v_mov_b32 v7, 0
    v_mov_b32 v8, 0
    v_mov_b32 v9, 0
    v_mov_b32 v10, 0
    v_mov_b32 v11, 0
    v_mov_b32 v12, 0
    v_mov_b32 v13, 0
    v_mov_b32 v14, 0
    v_mov_b32 v15, 0
    v_mov_b32 v16, 0
    v_mov_b32 v17, 0
    v_mov_b32 v18, 0
    v_mov_b32 v19, 0
    s_lshl_b32 s44, s56, 1
    s_add_u32 s44, s44, s59
    s_lshl_b32 s61, s57, 1
    s_add_u32 s61, s61, s60
    s_lshl_b32 s45, s44, 5
    s_lshl_b32 s46, s61, 1
    s_add_u32 s45, s45, s46
    s_lshl_b32 s45, s45, 10
    s_add_u32 s45, s45, 5242880
    buffer_load_dwordx4 v[64:67], v54, s[28:31], s45 offen offset:0 sc1
    buffer_load_dwordx4 v[68:71], v54, s[28:31], s45 offen offset:1024 sc1
    s_lshl_b32 s62, s44, 15
    s_lshl_b32 s46, s61, 6
    s_add_u32 s62, s62, s46
    s_lshr_b32 s63, s56, 1
    s_cmp_eq_u32 s24, 0
    s_cbranch_scc0 WAI3C
    s_lshl_b32 s46, s63, 11
    s_add_u32 s46, s46, 8192000
    s_add_u32 s44, s22, s46
    s_addc_u32 s45, s23, 0
    s_mov_b32 s54, 0
POL3C:
    s_load_dword s32, s[44:45], 0 glc
    s_load_dword s33, s[44:45], 128 glc
    s_load_dword s34, s[44:45], 256 glc
    s_load_dword s35, s[44:45], 384 glc
    s_load_dword s36, s[44:45], 512 glc
    s_load_dword s37, s[44:45], 640 glc
    s_load_dword s38, s[44:45], 768 glc
    s_load_dword s39, s[44:45], 896 glc
    s_load_dword s40, s[44:45], 1024 glc
    s_load_dword s41, s[44:45], 1152 glc
    s_load_dword s42, s[44:45], 1280 glc
    s_load_dword s43, s[44:45], 1408 glc
    s_load_dword s50, s[44:45], 1536 glc
    s_load_dword s51, s[44:45], 1664 glc
    s_waitcnt lgkmcnt(0)
    s_xor_b32 s46, s32, s26
    s_xor_b32 s33, s33, s26
    s_or_b32 s46, s46, s33
    s_xor_b32 s34, s34, s26
    s_or_b32 s46, s46, s34
    s_xor_b32 s35, s35, s26
    s_or_b32 s46, s46, s35
    s_xor_b32 s36, s36, s26
    s_or_b32 s46, s46, s36
    s_xor_b32 s37, s37, s26
    s_or_b32 s46, s46, s37
    s_xor_b32 s38, s38, s26
    s_or_b32 s46, s46, s38
    s_xor_b32 s39, s39, s26
    s_or_b32 s46, s46, s39
    s_xor_b32 s40, s40, s26
    s_or_b32 s46, s46, s40
    s_xor_b32 s41, s41, s26
    s_or_b32 s46, s46, s41
    s_xor_b32 s42, s42, s26
    s_or_b32 s46, s46, s42
    s_xor_b32 s43, s43, s26
    s_or_b32 s46, s46, s43
    s_xor_b32 s50, s50, s26
    s_or_b32 s46, s46, s50
    s_xor_b32 s51, s51, s26
    s_or_b32 s46, s46, s51
    s_cmp_eq_u32 s46, 0
    s_cbranch_scc1 WAI3C
    s_add_u32 s54, s54, 1
    s_cmp_lt_u32 s54, 40000
    s_cbranch_scc1 POL3C
WAI3C:
    s_barrier
    s_mov_b32 s36, s18
    s_and_b32 s37, s19, 0xffff
    s_mov_b32 s38, 2097152
    s_mov_b32 s39, 0x20000
    s_barrier
    ds_read_b128 v[20:23], v52 offset:0
    ds_read_b64_tr_b16 v[36:37], v53 offset:0
    ds_read_b64_tr_b16 v[38:39], v53 offset:512
    ds_read_b128 v[24:27], v52 offset:1024
    ds_read_b64_tr_b16 v[40:41], v53 offset:2048
    ds_read_b64_tr_b16 v[42:43], v53 offset:2560
    ds_read_b128 v[28:31], v52 offset:2048
    ds_read_b64_tr_b16 v[44:45], v53 offset:4096
    ds_read_b64_tr_b16 v[46:47], v53 offset:4608
    ds_read_b128 v[32:35], v52 offset:3072
    ds_read_b64_tr_b16 v[48:49], v53 offset:6144
    ds_read_b64_tr_b16 v[50:51], v53 offset:6656
    s_waitcnt lgkmcnt(9)
    v_mfma_f32_32x32x16_bf16 v[4:19], v[36:39], v[20:23], v[4:19]
    ds_read_b128 v[20:23], v52 offset:4096
    ds_read_b64_tr_b16 v[36:37], v53 offset:8192
    ds_read_b64_tr_b16 v[38:39], v53 offset:8704
    s_waitcnt lgkmcnt(9)
    v_mfma_f32_32x32x16_bf16 v[4:19], v[40:43], v[24:27], v[4:19]
    ds_read_b128 v[24:27], v52 offset:5120
    ds_read_b64_tr_b16 v[40:41], v53 offset:10240
    ds_read_b64_tr_b16 v[42:43], v53 offset:10752
    s_waitcnt lgkmcnt(9)
    v_mfma_f32_32x32x16_bf16 v[4:19], v[44:47], v[28:31], v[4:19]
    ds_read_b128 v[28:31], v52 offset:6144
    ds_read_b64_tr_b16 v[44:45], v53 offset:12288
    ds_read_b64_tr_b16 v[46:47], v53 offset:12800
    s_waitcnt lgkmcnt(9)
    v_mfma_f32_32x32x16_bf16 v[4:19], v[48:51], v[32:35], v[4:19]
    ds_read_b128 v[32:35], v52 offset:7168
    ds_read_b64_tr_b16 v[48:49], v53 offset:14336
    ds_read_b64_tr_b16 v[50:51], v53 offset:14848
    s_waitcnt lgkmcnt(9)
    v_mfma_f32_32x32x16_bf16 v[4:19], v[36:39], v[20:23], v[4:19]
    s_waitcnt lgkmcnt(0)
    s_barrier
    v_add_u32 v52, 0x4000, v52
    v_add_u32 v53, 0x4000, v53
    ds_read_b128 v[20:23], v52 offset:0
    ds_read_b64_tr_b16 v[36:37], v53 offset:0
    ds_read_b64_tr_b16 v[38:39], v53 offset:512
    v_mfma_f32_32x32x16_bf16 v[4:19], v[40:43], v[24:27], v[4:19]
    ds_read_b128 v[24:27], v52 offset:1024
    ds_read_b64_tr_b16 v[40:41], v53 offset:2048
    ds_read_b64_tr_b16 v[42:43], v53 offset:2560
    v_mfma_f32_32x32x16_bf16 v[4:19], v[44:47], v[28:31], v[4:19]
    ds_read_b128 v[28:31], v52 offset:2048
    ds_read_b64_tr_b16 v[44:45], v53 offset:4096
    ds_read_b64_tr_b16 v[46:47], v53 offset:4608
    v_mfma_f32_32x32x16_bf16 v[4:19], v[48:51], v[32:35], v[4:19]
    ds_read_b128 v[32:35], v52 offset:3072
    ds_read_b64_tr_b16 v[48:49], v53 offset:6144
    ds_read_b64_tr_b16 v[50:51], v53 offset:6656
    s_waitcnt lgkmcnt(9)
    v_mfma_f32_32x32x16_bf16 v[4:19], v[36:39], v[20:23], v[4:19]
    ds_read_b128 v[20:23], v52 offset:4096
    ds_read_b64_tr_b16 v[36:37], v53 offset:8192
    ds_read_b64_tr_b16 v[38:39], v53 offset:8704
    s_waitcnt lgkmcnt(9)
    v_mfma_f32_32x32x16_bf16 v[4:19], v[40:43], v[24:27], v[4:19]
    ds_read_b128 v[24:27], v52 offset:5120
    ds_read_b64_tr_b16 v[40:41], v53 offset:10240
    ds_read_b64_tr_b16 v[42:43], v53 offset:10752
    s_waitcnt lgkmcnt(9)
    v_mfma_f32_32x32x16_bf16 v[4:19], v[44:47], v[28:31], v[4:19]
    ds_read_b128 v[28:31], v52 offset:6144
    ds_read_b64_tr_b16 v[44:45], v53 offset:12288
    ds_read_b64_tr_b16 v[46:47], v53 offset:12800
    s_waitcnt lgkmcnt(9)
    v_mfma_f32_32x32x16_bf16 v[4:19], v[48:51], v[32:35], v[4:19]
    ds_read_b128 v[32:35], v52 offset:7168
    ds_read_b64_tr_b16 v[48:49], v53 offset:14336
    ds_read_b64_tr_b16 v[50:51], v53 offset:14848
    s_waitcnt lgkmcnt(9)
    v_mfma_f32_32x32x16_bf16 v[4:19], v[36:39], v[20:23], v[4:19]
    s_waitcnt lgkmcnt(0)
    s_barrier
    v_add_u32 v52, 0x4000, v52
    v_add_u32 v53, 0x4000, v53
    ds_read_b128 v[20:23], v52 offset:0
    ds_read_b64_tr_b16 v[36:37], v53 offset:0
    ds_read_b64_tr_b16 v[38:39], v53 offset:512
    v_mfma_f32_32x32x16_bf16 v[4:19], v[40:43], v[24:27], v[4:19]
    ds_read_b128 v[24:27], v52 offset:1024
    ds_read_b64_tr_b16 v[40:41], v53 offset:2048
    ds_read_b64_tr_b16 v[42:43], v53 offset:2560
    v_mfma_f32_32x32x16_bf16 v[4:19], v[44:47], v[28:31], v[4:19]
    ds_read_b128 v[28:31], v52 offset:2048
    ds_read_b64_tr_b16 v[44:45], v53 offset:4096
    ds_read_b64_tr_b16 v[46:47], v53 offset:4608
    v_mfma_f32_32x32x16_bf16 v[4:19], v[48:51], v[32:35], v[4:19]
    ds_read_b128 v[32:35], v52 offset:3072
    ds_read_b64_tr_b16 v[48:49], v53 offset:6144
    ds_read_b64_tr_b16 v[50:51], v53 offset:6656
    s_waitcnt lgkmcnt(9)
    v_mfma_f32_32x32x16_bf16 v[4:19], v[36:39], v[20:23], v[4:19]
    ds_read_b128 v[20:23], v52 offset:4096
    ds_read_b64_tr_b16 v[36:37], v53 offset:8192
    ds_read_b64_tr_b16 v[38:39], v53 offset:8704
    s_waitcnt lgkmcnt(9)
    v_mfma_f32_32x32x16_bf16 v[4:19], v[40:43], v[24:27], v[4:19]
    ds_read_b128 v[24:27], v52 offset:5120
    ds_read_b64_tr_b16 v[40:41], v53 offset:10240
    ds_read_b64_tr_b16 v[42:43], v53 offset:10752
    s_waitcnt lgkmcnt(9)
    v_mfma_f32_32x32x16_bf16 v[4:19], v[44:47], v[28:31], v[4:19]
    ds_read_b128 v[28:31], v52 offset:6144
    ds_read_b64_tr_b16 v[44:45], v53 offset:12288
    ds_read_b64_tr_b16 v[46:47], v53 offset:12800
    s_waitcnt lgkmcnt(9)
    v_mfma_f32_32x32x16_bf16 v[4:19], v[48:51], v[32:35], v[4:19]
    ds_read_b128 v[32:35], v52 offset:7168
    ds_read_b64_tr_b16 v[48:49], v53 offset:14336
    ds_read_b64_tr_b16 v[50:51], v53 offset:14848
    s_waitcnt lgkmcnt(9)
    v_mfma_f32_32x32x16_bf16 v[4:19], v[36:39], v[20:23], v[4:19]
    s_waitcnt lgkmcnt(0)
    s_barrier
    v_add_u32 v52, 0xffff8000, v52
    v_add_u32 v53, 0x4000, v53
    ds_read_b128 v[20:23], v52 offset:0
    ds_read_b64_tr_b16 v[36:37], v53 offset:0
    ds_read_b64_tr_b16 v[38:39], v53 offset:512
    v_mfma_f32_32x32x16_bf16 v[4:19], v[40:43], v[24:27], v[4:19]
    ds_read_b128 v[24:27], v52 offset:1024
    ds_read_b64_tr_b16 v[40:41], v53 offset:2048
    ds_read_b64_tr_b16 v[42:43], v53 offset:2560
    v_mfma_f32_32x32x16_bf16 v[4:19], v[44:47], v[28:31], v[4:19]
    ds_read_b128 v[28:31], v52 offset:2048
    ds_read_b64_tr_b16 v[44:45], v53 offset:4096
    ds_read_b64_tr_b16 v[46:47], v53 offset:4608
    v_mfma_f32_32x32x16_bf16 v[4:19], v[48:51], v[32:35], v[4:19]
    ds_read_b128 v[32:35], v52 offset:3072
    ds_read_b64_tr_b16 v[48:49], v53 offset:6144
    ds_read_b64_tr_b16 v[50:51], v53 offset:6656
    s_waitcnt lgkmcnt(9)
    v_mfma_f32_32x32x16_bf16 v[4:19], v[36:39], v[20:23], v[4:19]
    ds_read_b128 v[20:23], v52 offset:4096
    ds_read_b64_tr_b16 v[36:37], v53 offset:8192
    ds_read_b64_tr_b16 v[38:39], v53 offset:8704
    s_waitcnt lgkmcnt(9)
    v_mfma_f32_32x32x16_bf16 v[4:19], v[40:43], v[24:27], v[4:19]
    ds_read_b128 v[24:27], v52 offset:5120
    ds_read_b64_tr_b16 v[40:41], v53 offset:10240
    ds_read_b64_tr_b16 v[42:43], v53 offset:10752
    s_waitcnt lgkmcnt(9)
    v_mfma_f32_32x32x16_bf16 v[4:19], v[44:47], v[28:31], v[4:19]
    ds_read_b128 v[28:31], v52 offset:6144
    ds_read_b64_tr_b16 v[44:45], v53 offset:12288
    ds_read_b64_tr_b16 v[46:47], v53 offset:12800
    s_waitcnt lgkmcnt(9)
    v_mfma_f32_32x32x16_bf16 v[4:19], v[48:51], v[32:35], v[4:19]
    ds_read_b128 v[32:35], v52 offset:7168
    ds_read_b64_tr_b16 v[48:49], v53 offset:14336
    ds_read_b64_tr_b16 v[50:51], v53 offset:14848
    s_waitcnt lgkmcnt(9)
    v_mfma_f32_32x32x16_bf16 v[4:19], v[36:39], v[20:23], v[4:19]
    s_waitcnt lgkmcnt(0)
    s_barrier
    v_add_u32 v52, 0x4000, v52
    v_add_u32 v53, 0x4000, v53
    ds_read_b128 v[20:23], v52 offset:0
    ds_read_b64_tr_b16 v[36:37], v53 offset:0
    ds_read_b64_tr_b16 v[38:39], v53 offset:512
    v_mfma_f32_32x32x16_bf16 v[4:19], v[40:43], v[24:27], v[4:19]
    ds_read_b128 v[24:27], v52 offset:1024
    ds_read_b64_tr_b16 v[40:41], v53 offset:2048
    ds_read_b64_tr_b16 v[42:43], v53 offset:2560
    v_mfma_f32_32x32x16_bf16 v[4:19], v[44:47], v[28:31], v[4:19]
    ds_read_b128 v[28:31], v52 offset:2048
    ds_read_b64_tr_b16 v[44:45], v53 offset:4096
    ds_read_b64_tr_b16 v[46:47], v53 offset:4608
    v_mfma_f32_32x32x16_bf16 v[4:19], v[48:51], v[32:35], v[4:19]
    ds_read_b128 v[32:35], v52 offset:3072
    ds_read_b64_tr_b16 v[48:49], v53 offset:6144
    ds_read_b64_tr_b16 v[50:51], v53 offset:6656
    s_waitcnt lgkmcnt(9)
    v_mfma_f32_32x32x16_bf16 v[4:19], v[36:39], v[20:23], v[4:19]
    ds_read_b128 v[20:23], v52 offset:4096
    ds_read_b64_tr_b16 v[36:37], v53 offset:8192
    ds_read_b64_tr_b16 v[38:39], v53 offset:8704
    s_waitcnt lgkmcnt(9)
    v_mfma_f32_32x32x16_bf16 v[4:19], v[40:43], v[24:27], v[4:19]
    ds_read_b128 v[24:27], v52 offset:5120
    ds_read_b64_tr_b16 v[40:41], v53 offset:10240
    ds_read_b64_tr_b16 v[42:43], v53 offset:10752
    s_waitcnt lgkmcnt(9)
    v_mfma_f32_32x32x16_bf16 v[4:19], v[44:47], v[28:31], v[4:19]
    ds_read_b128 v[28:31], v52 offset:6144
    ds_read_b64_tr_b16 v[44:45], v53 offset:12288
    ds_read_b64_tr_b16 v[46:47], v53 offset:12800
    s_waitcnt lgkmcnt(9)
    v_mfma_f32_32x32x16_bf16 v[4:19], v[48:51], v[32:35], v[4:19]
    ds_read_b128 v[32:35], v52 offset:7168
    ds_read_b64_tr_b16 v[48:49], v53 offset:14336
    ds_read_b64_tr_b16 v[50:51], v53 offset:14848
    s_waitcnt lgkmcnt(9)
    v_mfma_f32_32x32x16_bf16 v[4:19], v[36:39], v[20:23], v[4:19]
    s_waitcnt lgkmcnt(0)
    s_barrier
    v_add_u32 v52, 0x4000, v52
    v_add_u32 v53, 0x4000, v53
    ds_read_b128 v[20:23], v52 offset:0
    ds_read_b64_tr_b16 v[36:37], v53 offset:0
    ds_read_b64_tr_b16 v[38:39], v53 offset:512
    v_mfma_f32_32x32x16_bf16 v[4:19], v[40:43], v[24:27], v[4:19]
    ds_read_b128 v[24:27], v52 offset:1024
    ds_read_b64_tr_b16 v[40:41], v53 offset:2048
    ds_read_b64_tr_b16 v[42:43], v53 offset:2560
    v_mfma_f32_32x32x16_bf16 v[4:19], v[44:47], v[28:31], v[4:19]
    ds_read_b128 v[28:31], v52 offset:2048
    ds_read_b64_tr_b16 v[44:45], v53 offset:4096
    ds_read_b64_tr_b16 v[46:47], v53 offset:4608
    v_mfma_f32_32x32x16_bf16 v[4:19], v[48:51], v[32:35], v[4:19]
    ds_read_b128 v[32:35], v52 offset:3072
    ds_read_b64_tr_b16 v[48:49], v53 offset:6144
    ds_read_b64_tr_b16 v[50:51], v53 offset:6656
    s_waitcnt lgkmcnt(9)
    v_mfma_f32_32x32x16_bf16 v[4:19], v[36:39], v[20:23], v[4:19]
    ds_read_b128 v[20:23], v52 offset:4096
    ds_read_b64_tr_b16 v[36:37], v53 offset:8192
    ds_read_b64_tr_b16 v[38:39], v53 offset:8704
    s_waitcnt lgkmcnt(9)
    v_mfma_f32_32x32x16_bf16 v[4:19], v[40:43], v[24:27], v[4:19]
    ds_read_b128 v[24:27], v52 offset:5120
    ds_read_b64_tr_b16 v[40:41], v53 offset:10240
    ds_read_b64_tr_b16 v[42:43], v53 offset:10752
    s_waitcnt lgkmcnt(9)
    v_mfma_f32_32x32x16_bf16 v[4:19], v[44:47], v[28:31], v[4:19]
    ds_read_b128 v[28:31], v52 offset:6144
    ds_read_b64_tr_b16 v[44:45], v53 offset:12288
    ds_read_b64_tr_b16 v[46:47], v53 offset:12800
    s_waitcnt lgkmcnt(9)
    v_mfma_f32_32x32x16_bf16 v[4:19], v[48:51], v[32:35], v[4:19]
    ds_read_b128 v[32:35], v52 offset:7168
    ds_read_b64_tr_b16 v[48:49], v53 offset:14336
    ds_read_b64_tr_b16 v[50:51], v53 offset:14848
    s_waitcnt lgkmcnt(9)
    v_mfma_f32_32x32x16_bf16 v[4:19], v[36:39], v[20:23], v[4:19]
    s_waitcnt lgkmcnt(0)
    s_barrier
    v_add_u32 v52, 0xffff8000, v52
    v_add_u32 v53, 0xfffec000, v53
    ds_read_b128 v[20:23], v52 offset:0
    ds_read_b64_tr_b16 v[36:37], v53 offset:0
    ds_read_b64_tr_b16 v[38:39], v53 offset:512
    v_mfma_f32_32x32x16_bf16 v[4:19], v[40:43], v[24:27], v[4:19]
    ds_read_b128 v[24:27], v52 offset:1024
    ds_read_b64_tr_b16 v[40:41], v53 offset:2048
    ds_read_b64_tr_b16 v[42:43], v53 offset:2560
    v_mfma_f32_32x32x16_bf16 v[4:19], v[44:47], v[28:31], v[4:19]
    ds_read_b128 v[28:31], v52 offset:2048
    ds_read_b64_tr_b16 v[44:45], v53 offset:4096
    ds_read_b64_tr_b16 v[46:47], v53 offset:4608
    v_mfma_f32_32x32x16_bf16 v[4:19], v[48:51], v[32:35], v[4:19]
    ds_read_b128 v[32:35], v52 offset:3072
    ds_read_b64_tr_b16 v[48:49], v53 offset:6144
    ds_read_b64_tr_b16 v[50:51], v53 offset:6656
    s_waitcnt lgkmcnt(9)
    v_mfma_f32_32x32x16_bf16 v[4:19], v[36:39], v[20:23], v[4:19]
    ds_read_b128 v[20:23], v52 offset:4096
    ds_read_b64_tr_b16 v[36:37], v53 offset:8192
    ds_read_b64_tr_b16 v[38:39], v53 offset:8704
    s_waitcnt lgkmcnt(9)
    v_mfma_f32_32x32x16_bf16 v[4:19], v[40:43], v[24:27], v[4:19]
    ds_read_b128 v[24:27], v52 offset:5120
    ds_read_b64_tr_b16 v[40:41], v53 offset:10240
    ds_read_b64_tr_b16 v[42:43], v53 offset:10752
    s_waitcnt lgkmcnt(9)
    v_mfma_f32_32x32x16_bf16 v[4:19], v[44:47], v[28:31], v[4:19]
    ds_read_b128 v[28:31], v52 offset:6144
    ds_read_b64_tr_b16 v[44:45], v53 offset:12288
    ds_read_b64_tr_b16 v[46:47], v53 offset:12800
    s_waitcnt lgkmcnt(9)
    v_mfma_f32_32x32x16_bf16 v[4:19], v[48:51], v[32:35], v[4:19]
    ds_read_b128 v[32:35], v52 offset:7168
    ds_read_b64_tr_b16 v[48:49], v53 offset:14336
    ds_read_b64_tr_b16 v[50:51], v53 offset:14848
    s_waitcnt lgkmcnt(9)
    v_mfma_f32_32x32x16_bf16 v[4:19], v[36:39], v[20:23], v[4:19]
    s_waitcnt lgkmcnt(0)
    s_barrier
    v_add_u32 v52, 0x4000, v52
    v_add_u32 v53, 0x4000, v53
    ds_read_b128 v[20:23], v52 offset:0
    ds_read_b64_tr_b16 v[36:37], v53 offset:0
    ds_read_b64_tr_b16 v[38:39], v53 offset:512
    v_mfma_f32_32x32x16_bf16 v[4:19], v[40:43], v[24:27], v[4:19]
    ds_read_b128 v[24:27], v52 offset:1024
    ds_read_b64_tr_b16 v[40:41], v53 offset:2048
    ds_read_b64_tr_b16 v[42:43], v53 offset:2560
    v_mfma_f32_32x32x16_bf16 v[4:19], v[44:47], v[28:31], v[4:19]
    ds_read_b128 v[28:31], v52 offset:2048
    ds_read_b64_tr_b16 v[44:45], v53 offset:4096
    ds_read_b64_tr_b16 v[46:47], v53 offset:4608
    v_mfma_f32_32x32x16_bf16 v[4:19], v[48:51], v[32:35], v[4:19]
    ds_read_b128 v[32:35], v52 offset:3072
    ds_read_b64_tr_b16 v[48:49], v53 offset:6144
    ds_read_b64_tr_b16 v[50:51], v53 offset:6656
    s_waitcnt lgkmcnt(9)
    v_mfma_f32_32x32x16_bf16 v[4:19], v[36:39], v[20:23], v[4:19]
    ds_read_b128 v[20:23], v52 offset:4096
    ds_read_b64_tr_b16 v[36:37], v53 offset:8192
    ds_read_b64_tr_b16 v[38:39], v53 offset:8704
    s_waitcnt lgkmcnt(9)
    v_mfma_f32_32x32x16_bf16 v[4:19], v[40:43], v[24:27], v[4:19]
    ds_read_b128 v[24:27], v52 offset:5120
    ds_read_b64_tr_b16 v[40:41], v53 offset:10240
    ds_read_b64_tr_b16 v[42:43], v53 offset:10752
    s_waitcnt lgkmcnt(9)
    v_mfma_f32_32x32x16_bf16 v[4:19], v[44:47], v[28:31], v[4:19]
    ds_read_b128 v[28:31], v52 offset:6144
    ds_read_b64_tr_b16 v[44:45], v53 offset:12288
    ds_read_b64_tr_b16 v[46:47], v53 offset:12800
    s_waitcnt lgkmcnt(9)
    v_mfma_f32_32x32x16_bf16 v[4:19], v[48:51], v[32:35], v[4:19]
    ds_read_b128 v[32:35], v52 offset:7168
    ds_read_b64_tr_b16 v[48:49], v53 offset:14336
    ds_read_b64_tr_b16 v[50:51], v53 offset:14848
    s_waitcnt lgkmcnt(9)
    v_mfma_f32_32x32x16_bf16 v[4:19], v[36:39], v[20:23], v[4:19]
    s_waitcnt lgkmcnt(0)
    s_barrier
    v_add_u32 v52, 0x4000, v52
    v_add_u32 v53, 0x4000, v53
    ds_read_b128 v[20:23], v52 offset:0
    ds_read_b64_tr_b16 v[36:37], v53 offset:0
    ds_read_b64_tr_b16 v[38:39], v53 offset:512
    v_mfma_f32_32x32x16_bf16 v[4:19], v[40:43], v[24:27], v[4:19]
    ds_read_b128 v[24:27], v52 offset:1024
    ds_read_b64_tr_b16 v[40:41], v53 offset:2048
    ds_read_b64_tr_b16 v[42:43], v53 offset:2560
    v_mfma_f32_32x32x16_bf16 v[4:19], v[44:47], v[28:31], v[4:19]
    ds_read_b128 v[28:31], v52 offset:2048
    ds_read_b64_tr_b16 v[44:45], v53 offset:4096
    ds_read_b64_tr_b16 v[46:47], v53 offset:4608
    v_mfma_f32_32x32x16_bf16 v[4:19], v[48:51], v[32:35], v[4:19]
    ds_read_b128 v[32:35], v52 offset:3072
    ds_read_b64_tr_b16 v[48:49], v53 offset:6144
    ds_read_b64_tr_b16 v[50:51], v53 offset:6656
    s_waitcnt lgkmcnt(9)
    v_mfma_f32_32x32x16_bf16 v[4:19], v[36:39], v[20:23], v[4:19]
    ds_read_b128 v[20:23], v52 offset:4096
    ds_read_b64_tr_b16 v[36:37], v53 offset:8192
    ds_read_b64_tr_b16 v[38:39], v53 offset:8704
    s_waitcnt lgkmcnt(9)
    v_mfma_f32_32x32x16_bf16 v[4:19], v[40:43], v[24:27], v[4:19]
    ds_read_b128 v[24:27], v52 offset:5120
    ds_read_b64_tr_b16 v[40:41], v53 offset:10240
    ds_read_b64_tr_b16 v[42:43], v53 offset:10752
    s_waitcnt lgkmcnt(9)
    v_mfma_f32_32x32x16_bf16 v[4:19], v[44:47], v[28:31], v[4:19]
    ds_read_b128 v[28:31], v52 offset:6144
    ds_read_b64_tr_b16 v[44:45], v53 offset:12288
    ds_read_b64_tr_b16 v[46:47], v53 offset:12800
    s_waitcnt lgkmcnt(9)
    v_mfma_f32_32x32x16_bf16 v[4:19], v[48:51], v[32:35], v[4:19]
    ds_read_b128 v[32:35], v52 offset:7168
    ds_read_b64_tr_b16 v[48:49], v53 offset:14336
    ds_read_b64_tr_b16 v[50:51], v53 offset:14848
    s_waitcnt lgkmcnt(9)
    v_mfma_f32_32x32x16_bf16 v[4:19], v[36:39], v[20:23], v[4:19]
    s_waitcnt lgkmcnt(0)
    s_barrier
    v_add_u32 v52, 0xffff8000, v52
    v_add_u32 v53, 0x4000, v53
    ds_read_b128 v[20:23], v52 offset:0
    ds_read_b64_tr_b16 v[36:37], v53 offset:0
    ds_read_b64_tr_b16 v[38:39], v53 offset:512
    v_mfma_f32_32x32x16_bf16 v[4:19], v[40:43], v[24:27], v[4:19]
    ds_read_b128 v[24:27], v52 offset:1024
    ds_read_b64_tr_b16 v[40:41], v53 offset:2048
    ds_read_b64_tr_b16 v[42:43], v53 offset:2560
    v_mfma_f32_32x32x16_bf16 v[4:19], v[44:47], v[28:31], v[4:19]
    ds_read_b128 v[28:31], v52 offset:2048
    ds_read_b64_tr_b16 v[44:45], v53 offset:4096
    ds_read_b64_tr_b16 v[46:47], v53 offset:4608
    v_mfma_f32_32x32x16_bf16 v[4:19], v[48:51], v[32:35], v[4:19]
    ds_read_b128 v[32:35], v52 offset:3072
    ds_read_b64_tr_b16 v[48:49], v53 offset:6144
    ds_read_b64_tr_b16 v[50:51], v53 offset:6656
    s_waitcnt lgkmcnt(9)
    v_mfma_f32_32x32x16_bf16 v[4:19], v[36:39], v[20:23], v[4:19]
    ds_read_b128 v[20:23], v52 offset:4096
    ds_read_b64_tr_b16 v[36:37], v53 offset:8192
    ds_read_b64_tr_b16 v[38:39], v53 offset:8704
    s_waitcnt lgkmcnt(9)
    v_mfma_f32_32x32x16_bf16 v[4:19], v[40:43], v[24:27], v[4:19]
    ds_read_b128 v[24:27], v52 offset:5120
    ds_read_b64_tr_b16 v[40:41], v53 offset:10240
    ds_read_b64_tr_b16 v[42:43], v53 offset:10752
    s_waitcnt lgkmcnt(9)
    v_mfma_f32_32x32x16_bf16 v[4:19], v[44:47], v[28:31], v[4:19]
    ds_read_b128 v[28:31], v52 offset:6144
    ds_read_b64_tr_b16 v[44:45], v53 offset:12288
    ds_read_b64_tr_b16 v[46:47], v53 offset:12800
    s_waitcnt lgkmcnt(9)
    v_mfma_f32_32x32x16_bf16 v[4:19], v[48:51], v[32:35], v[4:19]
    ds_read_b128 v[32:35], v52 offset:7168
    ds_read_b64_tr_b16 v[48:49], v53 offset:14336
    ds_read_b64_tr_b16 v[50:51], v53 offset:14848
    s_waitcnt lgkmcnt(9)
    v_mfma_f32_32x32x16_bf16 v[4:19], v[36:39], v[20:23], v[4:19]
    s_waitcnt lgkmcnt(0)
    s_barrier
    v_add_u32 v52, 0x4000, v52
    v_add_u32 v53, 0x4000, v53
    ds_read_b128 v[20:23], v52 offset:0
    ds_read_b64_tr_b16 v[36:37], v53 offset:0
    ds_read_b64_tr_b16 v[38:39], v53 offset:512
    v_mfma_f32_32x32x16_bf16 v[4:19], v[40:43], v[24:27], v[4:19]
    ds_read_b128 v[24:27], v52 offset:1024
    ds_read_b64_tr_b16 v[40:41], v53 offset:2048
    ds_read_b64_tr_b16 v[42:43], v53 offset:2560
    v_mfma_f32_32x32x16_bf16 v[4:19], v[44:47], v[28:31], v[4:19]
    ds_read_b128 v[28:31], v52 offset:2048
    ds_read_b64_tr_b16 v[44:45], v53 offset:4096
    ds_read_b64_tr_b16 v[46:47], v53 offset:4608
    v_mfma_f32_32x32x16_bf16 v[4:19], v[48:51], v[32:35], v[4:19]
    ds_read_b128 v[32:35], v52 offset:3072
    ds_read_b64_tr_b16 v[48:49], v53 offset:6144
    ds_read_b64_tr_b16 v[50:51], v53 offset:6656
    s_waitcnt lgkmcnt(9)
    v_mfma_f32_32x32x16_bf16 v[4:19], v[36:39], v[20:23], v[4:19]
    ds_read_b128 v[20:23], v52 offset:4096
    ds_read_b64_tr_b16 v[36:37], v53 offset:8192
    ds_read_b64_tr_b16 v[38:39], v53 offset:8704
    s_waitcnt lgkmcnt(9)
    v_mfma_f32_32x32x16_bf16 v[4:19], v[40:43], v[24:27], v[4:19]
    ds_read_b128 v[24:27], v52 offset:5120
    ds_read_b64_tr_b16 v[40:41], v53 offset:10240
    ds_read_b64_tr_b16 v[42:43], v53 offset:10752
    s_waitcnt lgkmcnt(9)
    v_mfma_f32_32x32x16_bf16 v[4:19], v[44:47], v[28:31], v[4:19]
    ds_read_b128 v[28:31], v52 offset:6144
    ds_read_b64_tr_b16 v[44:45], v53 offset:12288
    ds_read_b64_tr_b16 v[46:47], v53 offset:12800
    s_waitcnt lgkmcnt(9)
    v_mfma_f32_32x32x16_bf16 v[4:19], v[48:51], v[32:35], v[4:19]
    ds_read_b128 v[32:35], v52 offset:7168
    ds_read_b64_tr_b16 v[48:49], v53 offset:14336
    ds_read_b64_tr_b16 v[50:51], v53 offset:14848
    s_waitcnt lgkmcnt(9)
    v_mfma_f32_32x32x16_bf16 v[4:19], v[36:39], v[20:23], v[4:19]
    s_waitcnt lgkmcnt(0)
    s_barrier
    v_add_u32 v52, 0x4000, v52
    v_add_u32 v53, 0x4000, v53
    ds_read_b128 v[20:23], v52 offset:0
    ds_read_b64_tr_b16 v[36:37], v53 offset:0
    ds_read_b64_tr_b16 v[38:39], v53 offset:512
    v_mfma_f32_32x32x16_bf16 v[4:19], v[40:43], v[24:27], v[4:19]
    ds_read_b128 v[24:27], v52 offset:1024
    ds_read_b64_tr_b16 v[40:41], v53 offset:2048
    ds_read_b64_tr_b16 v[42:43], v53 offset:2560
    v_mfma_f32_32x32x16_bf16 v[4:19], v[44:47], v[28:31], v[4:19]
    ds_read_b128 v[28:31], v52 offset:2048
    ds_read_b64_tr_b16 v[44:45], v53 offset:4096
    ds_read_b64_tr_b16 v[46:47], v53 offset:4608
    v_mfma_f32_32x32x16_bf16 v[4:19], v[48:51], v[32:35], v[4:19]
    ds_read_b128 v[32:35], v52 offset:3072
    ds_read_b64_tr_b16 v[48:49], v53 offset:6144
    ds_read_b64_tr_b16 v[50:51], v53 offset:6656
    s_waitcnt lgkmcnt(9)
    v_mfma_f32_32x32x16_bf16 v[4:19], v[36:39], v[20:23], v[4:19]
    ds_read_b128 v[20:23], v52 offset:4096
    ds_read_b64_tr_b16 v[36:37], v53 offset:8192
    ds_read_b64_tr_b16 v[38:39], v53 offset:8704
    s_waitcnt lgkmcnt(9)
    v_mfma_f32_32x32x16_bf16 v[4:19], v[40:43], v[24:27], v[4:19]
    ds_read_b128 v[24:27], v52 offset:5120
    ds_read_b64_tr_b16 v[40:41], v53 offset:10240
    ds_read_b64_tr_b16 v[42:43], v53 offset:10752
    s_waitcnt lgkmcnt(9)
    v_mfma_f32_32x32x16_bf16 v[4:19], v[44:47], v[28:31], v[4:19]
    ds_read_b128 v[28:31], v52 offset:6144
    ds_read_b64_tr_b16 v[44:45], v53 offset:12288
    ds_read_b64_tr_b16 v[46:47], v53 offset:12800
    s_waitcnt lgkmcnt(9)
    v_mfma_f32_32x32x16_bf16 v[4:19], v[48:51], v[32:35], v[4:19]
    ds_read_b128 v[32:35], v52 offset:7168
    ds_read_b64_tr_b16 v[48:49], v53 offset:14336
    ds_read_b64_tr_b16 v[50:51], v53 offset:14848
    s_waitcnt lgkmcnt(9)
    v_mfma_f32_32x32x16_bf16 v[4:19], v[36:39], v[20:23], v[4:19]
    s_waitcnt lgkmcnt(0)
    s_barrier
    v_add_u32 v52, 0xffff8000, v52
    v_add_u32 v53, 0xfffec000, v53
    ds_read_b128 v[20:23], v52 offset:0
    ds_read_b64_tr_b16 v[36:37], v53 offset:0
    ds_read_b64_tr_b16 v[38:39], v53 offset:512
    v_mfma_f32_32x32x16_bf16 v[4:19], v[40:43], v[24:27], v[4:19]
    ds_read_b128 v[24:27], v52 offset:1024
    ds_read_b64_tr_b16 v[40:41], v53 offset:2048
    ds_read_b64_tr_b16 v[42:43], v53 offset:2560
    v_mfma_f32_32x32x16_bf16 v[4:19], v[44:47], v[28:31], v[4:19]
    ds_read_b128 v[28:31], v52 offset:2048
    ds_read_b64_tr_b16 v[44:45], v53 offset:4096
    ds_read_b64_tr_b16 v[46:47], v53 offset:4608
    v_mfma_f32_32x32x16_bf16 v[4:19], v[48:51], v[32:35], v[4:19]
    ds_read_b128 v[32:35], v52 offset:3072
    ds_read_b64_tr_b16 v[48:49], v53 offset:6144
    ds_read_b64_tr_b16 v[50:51], v53 offset:6656
    s_waitcnt lgkmcnt(9)
    v_mfma_f32_32x32x16_bf16 v[4:19], v[36:39], v[20:23], v[4:19]
    ds_read_b128 v[20:23], v52 offset:4096
    ds_read_b64_tr_b16 v[36:37], v53 offset:8192
    ds_read_b64_tr_b16 v[38:39], v53 offset:8704
    s_waitcnt lgkmcnt(9)
    v_mfma_f32_32x32x16_bf16 v[4:19], v[40:43], v[24:27], v[4:19]
    ds_read_b128 v[24:27], v52 offset:5120
    ds_read_b64_tr_b16 v[40:41], v53 offset:10240
    ds_read_b64_tr_b16 v[42:43], v53 offset:10752
    s_waitcnt lgkmcnt(9)
    v_mfma_f32_32x32x16_bf16 v[4:19], v[44:47], v[28:31], v[4:19]
    ds_read_b128 v[28:31], v52 offset:6144
    ds_read_b64_tr_b16 v[44:45], v53 offset:12288
    ds_read_b64_tr_b16 v[46:47], v53 offset:12800
    s_waitcnt lgkmcnt(9)
    v_mfma_f32_32x32x16_bf16 v[4:19], v[48:51], v[32:35], v[4:19]
    ds_read_b128 v[32:35], v52 offset:7168
    ds_read_b64_tr_b16 v[48:49], v53 offset:14336
    ds_read_b64_tr_b16 v[50:51], v53 offset:14848
    s_waitcnt lgkmcnt(9)
    v_mfma_f32_32x32x16_bf16 v[4:19], v[36:39], v[20:23], v[4:19]
    s_waitcnt lgkmcnt(0)
    s_barrier
    v_add_u32 v52, 0x4000, v52
    v_add_u32 v53, 0x4000, v53
    ds_read_b128 v[20:23], v52 offset:0
    ds_read_b64_tr_b16 v[36:37], v53 offset:0
    ds_read_b64_tr_b16 v[38:39], v53 offset:512
    v_mfma_f32_32x32x16_bf16 v[4:19], v[40:43], v[24:27], v[4:19]
    ds_read_b128 v[24:27], v52 offset:1024
    ds_read_b64_tr_b16 v[40:41], v53 offset:2048
    ds_read_b64_tr_b16 v[42:43], v53 offset:2560
    v_mfma_f32_32x32x16_bf16 v[4:19], v[44:47], v[28:31], v[4:19]
    ds_read_b128 v[28:31], v52 offset:2048
    ds_read_b64_tr_b16 v[44:45], v53 offset:4096
    ds_read_b64_tr_b16 v[46:47], v53 offset:4608
    v_mfma_f32_32x32x16_bf16 v[4:19], v[48:51], v[32:35], v[4:19]
    ds_read_b128 v[32:35], v52 offset:3072
    ds_read_b64_tr_b16 v[48:49], v53 offset:6144
    ds_read_b64_tr_b16 v[50:51], v53 offset:6656
    s_waitcnt lgkmcnt(9)
    v_mfma_f32_32x32x16_bf16 v[4:19], v[36:39], v[20:23], v[4:19]
    ds_read_b128 v[20:23], v52 offset:4096
    ds_read_b64_tr_b16 v[36:37], v53 offset:8192
    ds_read_b64_tr_b16 v[38:39], v53 offset:8704
    s_waitcnt lgkmcnt(9)
    v_mfma_f32_32x32x16_bf16 v[4:19], v[40:43], v[24:27], v[4:19]
    ds_read_b128 v[24:27], v52 offset:5120
    ds_read_b64_tr_b16 v[40:41], v53 offset:10240
    ds_read_b64_tr_b16 v[42:43], v53 offset:10752
    s_waitcnt lgkmcnt(9)
    v_mfma_f32_32x32x16_bf16 v[4:19], v[44:47], v[28:31], v[4:19]
    ds_read_b128 v[28:31], v52 offset:6144
    ds_read_b64_tr_b16 v[44:45], v53 offset:12288
    ds_read_b64_tr_b16 v[46:47], v53 offset:12800
    s_waitcnt lgkmcnt(9)
    v_mfma_f32_32x32x16_bf16 v[4:19], v[48:51], v[32:35], v[4:19]
    ds_read_b128 v[32:35], v52 offset:7168
    ds_read_b64_tr_b16 v[48:49], v53 offset:14336
    ds_read_b64_tr_b16 v[50:51], v53 offset:14848
    s_waitcnt lgkmcnt(9)
    v_mfma_f32_32x32x16_bf16 v[4:19], v[36:39], v[20:23], v[4:19]
    s_waitcnt lgkmcnt(6)
    v_mfma_f32_32x32x16_bf16 v[4:19], v[40:43], v[24:27], v[4:19]
    s_waitcnt lgkmcnt(3)
    v_mfma_f32_32x32x16_bf16 v[4:19], v[44:47], v[28:31], v[4:19]
    s_waitcnt lgkmcnt(0)
    v_mfma_f32_32x32x16_bf16 v[4:19], v[48:51], v[32:35], v[4:19]
    s_waitcnt vmcnt(0)
    s_nop 7
    s_nop 3
    v_lshlrev_b32 v56, 16, v64
    v_and_b32 v57, 0xffff0000, v64
    v_pk_add_f32 v[4:5], v[4:5], v[56:57]
    v_cvt_pk_bf16_f32 v64, v4, v5
    v_lshlrev_b32 v56, 16, v65
    v_and_b32 v57, 0xffff0000, v65
    v_pk_add_f32 v[6:7], v[6:7], v[56:57]
    v_cvt_pk_bf16_f32 v65, v6, v7
    v_lshlrev_b32 v56, 16, v66
    v_and_b32 v57, 0xffff0000, v66
    v_pk_add_f32 v[8:9], v[8:9], v[56:57]
    v_cvt_pk_bf16_f32 v66, v8, v9
    v_lshlrev_b32 v56, 16, v67
    v_and_b32 v57, 0xffff0000, v67
    v_pk_add_f32 v[10:11], v[10:11], v[56:57]
    v_cvt_pk_bf16_f32 v67, v10, v11
    v_lshlrev_b32 v56, 16, v68
    v_and_b32 v57, 0xffff0000, v68
    v_pk_add_f32 v[12:13], v[12:13], v[56:57]
    v_cvt_pk_bf16_f32 v68, v12, v13
    v_lshlrev_b32 v56, 16, v69
    v_and_b32 v57, 0xffff0000, v69
    v_pk_add_f32 v[14:15], v[14:15], v[56:57]
    v_cvt_pk_bf16_f32 v69, v14, v15
    v_lshlrev_b32 v56, 16, v70
    v_and_b32 v57, 0xffff0000, v70
    v_pk_add_f32 v[16:17], v[16:17], v[56:57]
    v_cvt_pk_bf16_f32 v70, v16, v17
    v_lshlrev_b32 v56, 16, v71
    v_and_b32 v57, 0xffff0000, v71
    v_pk_add_f32 v[18:19], v[18:19], v[56:57]
    v_cvt_pk_bf16_f32 v71, v18, v19
    v_and_b32 v56, 31, v0
    v_lshlrev_b32 v56, 10, v56
    v_lshrrev_b32 v57, 5, v0
    v_lshl_add_u32 v56, v57, 4, v56
    buffer_store_dwordx4 v[64:67], v56, s[36:39], s62 offen offset:0
    buffer_store_dwordx4 v[68:71], v56, s[36:39], s62 offen offset:32
    s_cmp_eq_u32 s2, 0
    s_cbranch_scc0 P4_NOEP
    s_cmp_eq_u32 s24, 0
    s_cbranch_scc0 P4_NOEP
    v_mov_b32 v58, 8323072
    v_mov_b32 v59, s26
    v_cmp_eq_u32 vcc, 0, v0
    s_and_saveexec_b64 s[48:49], vcc
    buffer_store_dword v59, v58, s[28:31], 0 offen sc1
    s_mov_b64 exec, s[48:49]
P4_NOEP:
ALL_EXIT:
    s_endpgm
ALL_END:
.section .rodata,"a"
.p2align 6
.amdhsa_kernel sequential_preLN__linear_kernel_hedgehog__glu_gated_glu__prompt_kernel
  .amdhsa_next_free_vgpr 256
  .amdhsa_next_free_sgpr 102
  .amdhsa_accum_offset 256
  .amdhsa_group_segment_fixed_size 0
  .amdhsa_kernarg_size 88
  .amdhsa_user_sgpr_count 2
  .amdhsa_user_sgpr_kernarg_segment_ptr 1
  .amdhsa_system_sgpr_workgroup_id_x 1
  .amdhsa_float_denorm_mode_32 3
.end_amdhsa_kernel
```
